```python
import torch

def _softmax(x, axis=-1):
    return torch.softmax(x, dim=axis)
def _gelu(x):
    return torch.nn.functional.gelu(x, approximate="tanh")
def _silu(x):
    return torch.nn.functional.silu(x)
def _sigmoid(x):
    return torch.sigmoid(x)
def _layernorm(x, axis=-1, eps=1e-5):
    m = x.mean(dim=axis, keepdim=True)
    v = x.var(dim=axis, keepdim=True, unbiased=False)
    return (x - m) / torch.sqrt(v + eps)
def _scatter_add(tgt, idx, src, axis=0):
    return tgt.clone().index_add_(axis, idx, src)
def _segment_sum(src, seg, n):
    out = torch.zeros((n,) + src.shape[1:], dtype=src.dtype)
    return out.index_add_(0, seg, src)
def _pad(x, pw):
    flat = tuple(v for pair in reversed(pw) for v in pair)
    return torch.nn.functional.pad(x, flat)

kernel_name = 'concat_heads__gqa_block_cached__gqa_block_cached__near_ridge'

def setup_inputs():

    _w = (lambda a: (lambda t: t.to(torch.bfloat16) if t.is_floating_point() else t)(torch.as_tensor(a)))
    def _A_setup():
        B, Sq, D = 16, 32, 640
        Hq, Hkv, Sk, Dh = 32, 32, 32, 192
        assert Hq % Hkv == 0, (Hq, Hkv)
        return {
            "x": _w((lambda *s: torch.randn(*s, dtype=torch.bfloat16) * 0.8)(B, Sq, D)),
            "k_cache": _w((lambda *s: torch.randn(*s, dtype=torch.bfloat16) * 0.8)(B, Hkv, Sk, Dh)),
            "v_cache": _w((lambda *s: torch.randn(*s, dtype=torch.bfloat16) * 0.05)(B, Hkv, Sk, Dh)),
            "wq": _w((lambda *s: torch.randn(*s, dtype=torch.bfloat16) * 0.8)(D, Hq * Dh) * (D ** -0.5)),
            "wo": _w((lambda *s: torch.randn(*s, dtype=torch.bfloat16) * 0.05)(Hq * Dh, D) * ((Hq * Dh) ** -0.5)),
        }
    _A_in = _A_setup()

    def _B_setup():
        B, Sq, D = 16, 32, 640
        Hq, Hkv, Sk, Dh = 32, 32, 32, 192
        assert Hq % Hkv == 0, (Hq, Hkv)
        return {
            "x": _w((lambda *s: torch.randn(*s, dtype=torch.bfloat16) * 0.8)(B, Sq, D)),
            "k_cache": _w((lambda *s: torch.randn(*s, dtype=torch.bfloat16) * 0.8)(B, Hkv, Sk, Dh)),
            "v_cache": _w((lambda *s: torch.randn(*s, dtype=torch.bfloat16) * 0.05)(B, Hkv, Sk, Dh)),
            "wq": _w((lambda *s: torch.randn(*s, dtype=torch.bfloat16) * 0.8)(D, Hq * Dh) * (D ** -0.5)),
            "wo": _w((lambda *s: torch.randn(*s, dtype=torch.bfloat16) * 0.05)(Hq * Dh, D) * ((Hq * Dh) ** -0.5)),
        }
    _B_in = _B_setup()

    return {
        "A_x": _A_in["x"],
        "A_k_cache": _A_in["k_cache"],
        "A_v_cache": _A_in["v_cache"],
        "A_wq": _A_in["wq"],
        "A_wo": _A_in["wo"],
        "B_x": _B_in["x"],
        "B_k_cache": _B_in["k_cache"],
        "B_v_cache": _B_in["v_cache"],
        "B_wq": _B_in["wq"],
        "B_wo": _B_in["wo"],
    }

def reference(A_x, A_k_cache, A_v_cache, A_wq, A_wo, B_x, B_k_cache, B_v_cache, B_wq, B_wo):
    def _A_ref(x, k_cache, v_cache, wq, wo):
        B, Sq, D = x.shape
        Hq, Dh = 32, 192
        Hkv = k_cache.shape[1]
        rep = Hq // Hkv
        q = (lambda x, *d: x.permute(*d))((x @ wq).reshape(B, Sq, Hq, Dh), 0, 2, 1, 3)
        k = (lambda x, n, axis: torch.repeat_interleave(x, n, dim=axis))(k_cache, rep, axis=1)
        v = (lambda x, n, axis: torch.repeat_interleave(x, n, dim=axis))(v_cache, rep, axis=1)
        scores = torch.einsum("bhqd,bhkd->bhqk", q, k) * (Dh ** -0.5)
        p = _softmax(scores, axis=-1)
        o = torch.einsum("bhqk,bhkd->bhqd", p, v)
        return (lambda x, *d: x.permute(*d))(o, 0, 2, 1, 3).reshape(B, Sq, Hq * Dh) @ wo

    def _B_ref(x, k_cache, v_cache, wq, wo):
        B, Sq, D = x.shape
        Hq, Dh = 32, 192
        Hkv = k_cache.shape[1]
        rep = Hq // Hkv
        q = (lambda x, *d: x.permute(*d))((x @ wq).reshape(B, Sq, Hq, Dh), 0, 2, 1, 3)
        k = (lambda x, n, axis: torch.repeat_interleave(x, n, dim=axis))(k_cache, rep, axis=1)
        v = (lambda x, n, axis: torch.repeat_interleave(x, n, dim=axis))(v_cache, rep, axis=1)
        scores = torch.einsum("bhqd,bhkd->bhqk", q, k) * (Dh ** -0.5)
        p = _softmax(scores, axis=-1)
        o = torch.einsum("bhqk,bhkd->bhqd", p, v)
        return (lambda x, *d: x.permute(*d))(o, 0, 2, 1, 3).reshape(B, Sq, Hq * Dh) @ wo

    a = _A_ref(A_x, A_k_cache, A_v_cache, A_wq, A_wo)
    b = _B_ref(B_x, B_k_cache, B_v_cache, B_wq, B_wo)
    return torch.concatenate([a, b], axis=-1)
```

```asm
; @launch grid=(256,1,1) block=(512,1,1) lds=163840
.amdgcn_target "amdgcn-amd-amdhsa--gfx950"
.text
.globl concat_heads__gqa_block_cached__gqa_block_cached__near_ridge_kernel
.p2align 8
.type concat_heads__gqa_block_cached__gqa_block_cached__near_ridge_kernel,@function
concat_heads__gqa_block_cached__gqa_block_cached__near_ridge_kernel:
  s_cmp_ge_u32 s2, 256
  s_cbranch_scc1 L_exit
  s_and_b32 s44, s2, 7
  s_lshr_b32 s36, s44, 2
  s_mul_i32 s45, s36, 40
  s_load_dwordx8 s[76:83], s[0:1], s45
  s_getpc_b64 s[72:73]
L_pc:
  s_lshr_b32 s46, s2, 3
  v_lshrrev_b32 v1, 5, v0
  v_lshl_add_u32 v1, s46, 4, v1
  v_min_u32 v1, (L_end-L_pc)/128-1, v1
  v_lshlrev_b32 v1, 7, v1
  global_load_dword v156, v1, s[72:73]
  v_lshrrev_b32 v1, 6, v0
  v_and_b32 v0, 63, v0
  s_and_b32 s44, s44, 3
  v_readfirstlane_b32 s3, v1
  s_lshr_b32 s43, s2, 5
  s_bfe_u32 s37, s2, 0x20003
  s_lshl3_add_u32 s38, s44, s43
  s_and_b32 s41, s3, 3
  s_cmp_lt_u32 s3, 4
  s_cbranch_scc1 L_compute
  v_lshrrev_b32 v1, 3, v0
  v_and_b32 v2, 7, v0
  v_and_b32 v3, 2, v1
  v_xor_b32 v3, v2, v3
  v_lshlrev_b32 v3, 4, v3
  v_mul_u32_u24 v7, 12288, v1
  v_add_u32 v16, v7, v3
  v_add_u32 v17, 98304, v16
  s_mul_i32 s54, s41, 3072
  s_lshl_b32 s50, s41, 9
  s_add_u32 s50, s50, s38
  s_mul_i32 s50, s50, 384
  s_mov_b32 s10, 7864320
  s_mov_b32 s11, 0x00020000
  s_waitcnt lgkmcnt(0)
  s_mov_b64 s[8:9], s[82:83]
  s_add_u32 m0, s54, 98560
  s_nop 0
  buffer_load_dwordx4 v16, s[8:11], s50 offen  lds
  s_add_u32 m0, s54, 99456
  s_nop 0
  buffer_load_dwordx4 v16, s[8:11], s50 offen offset:128  lds
  s_add_u32 m0, s54, 100352
  s_nop 0
  buffer_load_dwordx4 v16, s[8:11], s50 offen offset:256  lds
  s_add_u32 m0, s54, 110912
  s_nop 0
  buffer_load_dwordx4 v17, s[8:11], s50 offen  lds
  s_add_u32 m0, s54, 111808
  s_nop 0
  buffer_load_dwordx4 v17, s[8:11], s50 offen offset:128  lds
  s_add_u32 m0, s54, 112704
  s_nop 0
  buffer_load_dwordx4 v17, s[8:11], s50 offen offset:256  lds
  s_mul_i32 s45, s36, 40
  s_load_dwordx2 s[88:89], s[0:1], 96
  s_load_dwordx2 s[84:85], s[0:1], s45 offset:32
  s_load_dwordx2 s[86:87], s[0:1], 80
  s_lshr_b32 s39, s38, 2
  s_and_b32 s42, s43, 3
  s_mov_b32 s40, s42
  s_lshl2_add_u32 s33, s36, s37
  s_lshl_b32 s35, s33, 8
  s_add_u32 s35, s35, 16777216
  v_lshrrev_b32 v4, 1, v1
  v_xor_b32 v4, v2, v4
  v_xor_b32 v5, 4, v4
  v_lshlrev_b32 v4, 4, v4
  v_lshlrev_b32 v5, 4, v5
  v_mul_u32_u24 v6, 1280, v1
  v_add_u32 v8, v6, v4
  v_add_u32 v9, v6, v5
  v_add_u32 v9, 10240, v9
  v_add_u32 v10, v6, v4
  v_add_u32 v10, 20480, v10
  v_add_u32 v11, v6, v5
  v_add_u32 v11, 30720, v11
  s_lshl_b32 s53, s41, 12
  s_lshl2_add_u32 s44, s37, s41
  s_mul_i32 s49, s44, 40960
  s_mul_i32 s56, s44, 393216
  s_mov_b32 s4, s76
  s_mov_b32 s5, s77
  s_mov_b32 s6, 655360
  s_mov_b32 s7, 0x00020000
  s_add_u32 m0, s53, 82176
  s_nop 0
  buffer_load_dwordx4 v8, s[4:7], s49 offen  lds
  s_add_u32 m0, s53, 83200
  s_nop 0
  buffer_load_dwordx4 v9, s[4:7], s49 offen  lds
  s_add_u32 m0, s53, 84224
  s_nop 0
  buffer_load_dwordx4 v10, s[4:7], s49 offen  lds
  s_add_u32 m0, s53, 85248
  s_nop 0
  buffer_load_dwordx4 v11, s[4:7], s49 offen  lds
  v_mul_u32_u24 v7, 384, v1
  v_add_u32 v12, v7, v4
  v_add_u32 v13, v7, v5
  v_add_u32 v13, 3072, v13
  v_add_u32 v14, v7, v4
  v_add_u32 v14, 6144, v14
  v_add_u32 v15, v7, v5
  v_add_u32 v15, 9216, v15
  v_add_u32 v18, v6, v3
  v_add_u32 v19, 10240, v18
  v_lshrrev_b32 v1, 2, v0
  v_lshrrev_b32 v3, 4, v0
  v_and_b32 v3, 2, v3
  v_and_b32 v2, 3, v0
  v_xor_b32 v2, v2, v3
  v_mul_u32_u24 v1, 1280, v1
  v_lshl_add_u32 v20, v2, 4, v1
  s_lshl_b32 s55, s41, 10
  s_lshl_b32 s66, s41, 11
  s_mul_i32 s64, s38, 12288
  s_add_u32 s64, s64, s56
  s_lshl_b32 s62, s39, 2
  s_mul_i32 s65, s62, 12288
  s_add_u32 s65, s65, s56
  s_mul_i32 s47, s62, 245760
  s_mul_i32 s44, s40, 320
  s_and_b32 s45, s40, 1
  s_lshl_b32 s46, s45, 6
  s_add_u32 s60, s44, s46
  s_xor_b32 s45, s45, 1
  s_lshl_b32 s46, s45, 8
  s_add_u32 s61, s44, s46
  s_mul_i32 s44, s41, 20480
  s_add_u32 s44, s44, s47
  s_add_u32 s60, s60, s44
  s_add_u32 s61, s61, s44
  s_add_u32 s63, s37, s43
  s_and_b32 s63, s63, 3
  s_and_b32 s44, s38, 4
  s_or_b32 s63, s63, s44
  s_mov_b32 s67, 0x68532410
  s_mov_b32 s51, 0x67543201
  s_mov_b32 s52, 0x97ba98
  s_mov_b32 s57, 0x10400
  s_cmp_eq_u32 s63, 1
  s_cselect_b32 s67, 0x96435210, s67
  s_cselect_b32 s51, 0x9a210534, s51
  s_cselect_b32 s52, 0x87876b, s52
  s_cmp_eq_u32 s63, 2
  s_cselect_b32 s67, 0x75463120, s67
  s_cselect_b32 s51, 0x86543120, s51
  s_cselect_b32 s52, 0x98ba97, s52
  s_cselect_b32 s57, 0x30c00, s57
  s_cmp_eq_u32 s63, 3
  s_cselect_b32 s67, 0x65742130, s67
  s_cselect_b32 s51, 0xb9210453, s51
  s_cselect_b32 s52, 0x98876a, s52
  s_cselect_b32 s57, 0x30c00, s57
  s_cmp_eq_u32 s63, 4
  s_cselect_b32 s51, 0x76534210, s51
  s_cselect_b32 s57, 0x82400, s57
  s_cmp_eq_u32 s63, 5
  s_cselect_b32 s67, 0x96435210, s67
  s_cselect_b32 s51, 0x43867021, s51
  s_cselect_b32 s52, 0x879ba5, s52
  s_cselect_b32 s57, 0x82400, s57
  s_cmp_eq_u32 s63, 6
  s_cselect_b32 s67, 0x75463120, s67
  s_cselect_b32 s51, 0x76453102, s51
  s_cselect_b32 s52, 0x98a9b8, s52
  s_cselect_b32 s57, 0x86400, s57
  s_cmp_eq_u32 s63, 7
  s_cselect_b32 s67, 0x65742130, s67
  s_cselect_b32 s51, 0x43786210, s51
  s_cselect_b32 s52, 0x98ba95, s52
  s_cselect_b32 s57, 0x86400, s57
  s_mov_b32 s12, s78
  s_mov_b32 s13, s79
  s_mov_b32 s14, 6291456
  s_mov_b32 s15, 0x00020000
  s_mov_b32 s16, s80
  s_mov_b32 s17, s81
  s_mov_b32 s18, 6291456
  s_mov_b32 s19, 0x00020000
  s_waitcnt lgkmcnt(0)
  s_mov_b32 s20, s84
  s_mov_b32 s21, s85
  s_mov_b32 s22, 7864320
  s_mov_b32 s23, 0x00020000
  s_mov_b32 s28, s88
  s_mov_b32 s29, s89
  s_mov_b32 s30, 268435456
  s_mov_b32 s31, 0x00020000
  s_load_dword s32, s[88:89], s35
  s_bfe_u32 s48, s67, 0x40004
  s_mul_i32 s79, s48, 786432
  s_add_u32 s79, s79, s50
  s_lshl_b32 s80, s48, 7
  s_add_u32 s80, s80, s49
  s_add_u32 m0, s54, 16384
  s_nop 0
  buffer_load_dwordx4 v16, s[8:11], s79 offen  lds
  s_add_u32 m0, s54, 17280
  s_nop 0
  buffer_load_dwordx4 v16, s[8:11], s79 offen offset:128  lds
  s_add_u32 m0, s54, 18176
  s_nop 0
  buffer_load_dwordx4 v16, s[8:11], s79 offen offset:256  lds
  s_add_u32 m0, s54, 28736
  s_nop 0
  buffer_load_dwordx4 v17, s[8:11], s79 offen  lds
  s_add_u32 m0, s54, 29632
  s_nop 0
  buffer_load_dwordx4 v17, s[8:11], s79 offen offset:128  lds
  s_add_u32 m0, s54, 30528
  s_nop 0
  buffer_load_dwordx4 v17, s[8:11], s79 offen offset:256  lds
  s_add_u32 m0, s53, 0
  s_nop 0
  buffer_load_dwordx4 v8, s[4:7], s80 offen  lds
  s_add_u32 m0, s53, 1024
  s_nop 0
  buffer_load_dwordx4 v9, s[4:7], s80 offen  lds
  s_add_u32 m0, s53, 2048
  s_nop 0
  buffer_load_dwordx4 v10, s[4:7], s80 offen  lds
  s_add_u32 m0, s53, 3072
  s_nop 0
  buffer_load_dwordx4 v11, s[4:7], s80 offen  lds
  s_waitcnt vmcnt(10)
  s_barrier
  s_add_u32 m0, s53, 123264
  s_nop 0
  buffer_load_dwordx4 v12, s[12:15], s64 offen nt lds
  s_add_u32 m0, s53, 124288
  s_nop 0
  buffer_load_dwordx4 v13, s[12:15], s64 offen nt lds
  s_add_u32 m0, s53, 125312
  s_nop 0
  buffer_load_dwordx4 v14, s[12:15], s64 offen nt lds
  s_bfe_u32 s48, s67, 0x40008
  s_mul_i32 s82, s48, 786432
  s_add_u32 s82, s82, s50
  s_lshl_b32 s83, s48, 7
  s_add_u32 s83, s83, s49
  s_add_u32 m0, s54, 57472
  s_nop 0
  buffer_load_dwordx4 v16, s[8:11], s82 offen  lds
  s_add_u32 m0, s54, 58368
  s_nop 0
  buffer_load_dwordx4 v16, s[8:11], s82 offen offset:128  lds
  s_add_u32 m0, s54, 59264
  s_nop 0
  buffer_load_dwordx4 v16, s[8:11], s82 offen offset:256  lds
  s_add_u32 m0, s54, 69824
  s_nop 0
  buffer_load_dwordx4 v17, s[8:11], s82 offen  lds
  s_add_u32 m0, s54, 70720
  s_nop 0
  buffer_load_dwordx4 v17, s[8:11], s82 offen offset:128  lds
  s_add_u32 m0, s54, 71616
  s_nop 0
  buffer_load_dwordx4 v17, s[8:11], s82 offen offset:256  lds
  s_add_u32 m0, s53, 41088
  s_nop 0
  buffer_load_dwordx4 v8, s[4:7], s83 offen  lds
  s_add_u32 m0, s53, 42112
  s_nop 0
  buffer_load_dwordx4 v9, s[4:7], s83 offen  lds
  s_add_u32 m0, s53, 43136
  s_nop 0
  buffer_load_dwordx4 v10, s[4:7], s83 offen  lds
  s_add_u32 m0, s53, 44160
  s_nop 0
  buffer_load_dwordx4 v11, s[4:7], s83 offen  lds
  s_waitcnt lgkmcnt(0)
  s_add_u32 s32, s32, 0x9e3779b9
  s_bfe_u32 s48, s67, 0x4000c
  s_mul_i32 s76, s48, 786432
  s_add_u32 s76, s76, s50
  s_lshl_b32 s77, s48, 7
  s_add_u32 s77, s77, s49
  s_waitcnt vmcnt(13)
  s_barrier
  s_add_u32 m0, s53, 126336
  s_nop 0
  buffer_load_dwordx4 v15, s[12:15], s64 offen nt lds
  s_add_u32 m0, s53, 139520
  s_nop 0
  buffer_load_dwordx4 v12, s[12:15], s64 offen offset:128 nt lds
  s_add_u32 m0, s53, 140544
  s_nop 0
  buffer_load_dwordx4 v13, s[12:15], s64 offen offset:128 nt lds
  s_add_u32 m0, s54, 98560
  s_nop 0
  buffer_load_dwordx4 v16, s[8:11], s76 offen  lds
  s_add_u32 m0, s54, 99456
  s_nop 0
  buffer_load_dwordx4 v16, s[8:11], s76 offen offset:128  lds
  s_add_u32 m0, s54, 100352
  s_nop 0
  buffer_load_dwordx4 v16, s[8:11], s76 offen offset:256  lds
  s_add_u32 m0, s54, 110912
  s_nop 0
  buffer_load_dwordx4 v17, s[8:11], s76 offen  lds
  s_add_u32 m0, s54, 111808
  s_nop 0
  buffer_load_dwordx4 v17, s[8:11], s76 offen offset:128  lds
  s_add_u32 m0, s54, 112704
  s_nop 0
  buffer_load_dwordx4 v17, s[8:11], s76 offen offset:256  lds
  s_add_u32 m0, s53, 82176
  s_nop 0
  buffer_load_dwordx4 v8, s[4:7], s77 offen  lds
  s_add_u32 m0, s53, 83200
  s_nop 0
  buffer_load_dwordx4 v9, s[4:7], s77 offen  lds
  s_add_u32 m0, s53, 84224
  s_nop 0
  buffer_load_dwordx4 v10, s[4:7], s77 offen  lds
  s_add_u32 m0, s53, 85248
  s_nop 0
  buffer_load_dwordx4 v11, s[4:7], s77 offen  lds
  s_bfe_u32 s48, s67, 0x40010
  s_mul_i32 s79, s48, 786432
  s_add_u32 s79, s79, s50
  s_lshl_b32 s80, s48, 7
  s_add_u32 s80, s80, s49
  s_waitcnt vmcnt(13)
  s_barrier
  s_add_u32 m0, s53, 141568
  s_nop 0
  buffer_load_dwordx4 v14, s[12:15], s64 offen offset:128 nt lds
  s_add_u32 m0, s53, 142592
  s_nop 0
  buffer_load_dwordx4 v15, s[12:15], s64 offen offset:128 nt lds
  s_add_u32 m0, s54, 16384
  s_nop 0
  buffer_load_dwordx4 v16, s[8:11], s79 offen  lds
  s_add_u32 m0, s54, 17280
  s_nop 0
  buffer_load_dwordx4 v16, s[8:11], s79 offen offset:128  lds
  s_add_u32 m0, s54, 18176
  s_nop 0
  buffer_load_dwordx4 v16, s[8:11], s79 offen offset:256  lds
  s_add_u32 m0, s54, 28736
  s_nop 0
  buffer_load_dwordx4 v17, s[8:11], s79 offen  lds
  s_add_u32 m0, s54, 29632
  s_nop 0
  buffer_load_dwordx4 v17, s[8:11], s79 offen offset:128  lds
  s_add_u32 m0, s54, 30528
  s_nop 0
  buffer_load_dwordx4 v17, s[8:11], s79 offen offset:256  lds
  s_add_u32 m0, s53, 0
  s_nop 0
  buffer_load_dwordx4 v8, s[4:7], s80 offen  lds
  s_add_u32 m0, s53, 1024
  s_nop 0
  buffer_load_dwordx4 v9, s[4:7], s80 offen  lds
  s_add_u32 m0, s53, 2048
  s_nop 0
  buffer_load_dwordx4 v10, s[4:7], s80 offen  lds
  s_add_u32 m0, s53, 3072
  s_nop 0
  buffer_load_dwordx4 v11, s[4:7], s80 offen  lds
  s_bfe_u32 s48, s67, 0x40014
  s_mul_i32 s82, s48, 786432
  s_add_u32 s82, s82, s50
  s_lshl_b32 s83, s48, 7
  s_add_u32 s83, s83, s49
  s_waitcnt vmcnt(12)
  s_barrier
  s_add_u32 m0, s54, 57472
  s_nop 0
  buffer_load_dwordx4 v16, s[8:11], s82 offen  lds
  s_add_u32 m0, s54, 58368
  s_nop 0
  buffer_load_dwordx4 v16, s[8:11], s82 offen offset:128  lds
  s_add_u32 m0, s54, 59264
  s_nop 0
  buffer_load_dwordx4 v16, s[8:11], s82 offen offset:256  lds
  s_add_u32 m0, s54, 69824
  s_nop 0
  buffer_load_dwordx4 v17, s[8:11], s82 offen  lds
  s_add_u32 m0, s54, 70720
  s_nop 0
  buffer_load_dwordx4 v17, s[8:11], s82 offen offset:128  lds
  s_add_u32 m0, s54, 71616
  s_nop 0
  buffer_load_dwordx4 v17, s[8:11], s82 offen offset:256  lds
  s_add_u32 m0, s53, 41088
  s_nop 0
  buffer_load_dwordx4 v8, s[4:7], s83 offen  lds
  s_add_u32 m0, s53, 42112
  s_nop 0
  buffer_load_dwordx4 v9, s[4:7], s83 offen  lds
  s_add_u32 m0, s53, 43136
  s_nop 0
  buffer_load_dwordx4 v10, s[4:7], s83 offen  lds
  s_add_u32 m0, s53, 44160
  s_nop 0
  buffer_load_dwordx4 v11, s[4:7], s83 offen  lds
  s_bfe_u32 s48, s67, 0x40018
  s_mul_i32 s76, s48, 786432
  s_add_u32 s76, s76, s50
  s_lshl_b32 s77, s48, 7
  s_add_u32 s77, s77, s49
  s_waitcnt vmcnt(10)
  s_barrier
  s_add_u32 m0, s54, 98560
  s_nop 0
  buffer_load_dwordx4 v16, s[8:11], s76 offen  lds
  s_add_u32 m0, s54, 99456
  s_nop 0
  buffer_load_dwordx4 v16, s[8:11], s76 offen offset:128  lds
  s_add_u32 m0, s54, 100352
  s_nop 0
  buffer_load_dwordx4 v16, s[8:11], s76 offen offset:256  lds
  s_add_u32 m0, s54, 110912
  s_nop 0
  buffer_load_dwordx4 v17, s[8:11], s76 offen  lds
  s_add_u32 m0, s54, 111808
  s_nop 0
  buffer_load_dwordx4 v17, s[8:11], s76 offen offset:128  lds
  s_add_u32 m0, s54, 112704
  s_nop 0
  buffer_load_dwordx4 v17, s[8:11], s76 offen offset:256  lds
  s_add_u32 m0, s53, 82176
  s_nop 0
  buffer_load_dwordx4 v8, s[4:7], s77 offen  lds
  s_add_u32 m0, s53, 83200
  s_nop 0
  buffer_load_dwordx4 v9, s[4:7], s77 offen  lds
  s_add_u32 m0, s53, 84224
  s_nop 0
  buffer_load_dwordx4 v10, s[4:7], s77 offen  lds
  s_add_u32 m0, s53, 85248
  s_nop 0
  buffer_load_dwordx4 v11, s[4:7], s77 offen  lds
  s_bfe_u32 s48, s67, 0x4001c
  s_mul_i32 s79, s48, 786432
  s_add_u32 s79, s79, s50
  s_lshl_b32 s80, s48, 7
  s_add_u32 s80, s80, s49
  s_waitcnt vmcnt(10)
  s_barrier
  s_add_u32 m0, s54, 16384
  s_nop 0
  buffer_load_dwordx4 v16, s[8:11], s79 offen  lds
  s_add_u32 m0, s54, 17280
  s_nop 0
  buffer_load_dwordx4 v16, s[8:11], s79 offen offset:128  lds
  s_add_u32 m0, s54, 18176
  s_nop 0
  buffer_load_dwordx4 v16, s[8:11], s79 offen offset:256  lds
  s_add_u32 m0, s54, 28736
  s_nop 0
  buffer_load_dwordx4 v17, s[8:11], s79 offen  lds
  s_add_u32 m0, s54, 29632
  s_nop 0
  buffer_load_dwordx4 v17, s[8:11], s79 offen offset:128  lds
  s_add_u32 m0, s54, 30528
  s_nop 0
  buffer_load_dwordx4 v17, s[8:11], s79 offen offset:256  lds
  s_add_u32 m0, s53, 0
  s_nop 0
  buffer_load_dwordx4 v8, s[4:7], s80 offen  lds
  s_add_u32 m0, s53, 1024
  s_nop 0
  buffer_load_dwordx4 v9, s[4:7], s80 offen  lds
  s_add_u32 m0, s53, 2048
  s_nop 0
  buffer_load_dwordx4 v10, s[4:7], s80 offen  lds
  s_add_u32 m0, s53, 3072
  s_nop 0
  buffer_load_dwordx4 v11, s[4:7], s80 offen  lds
  s_add_u32 m0, s53, 123008
  s_nop 0
  buffer_load_dwordx4 v12, s[12:15], s64 offen offset:256 nt lds
  s_add_u32 m0, s53, 124032
  s_nop 0
  buffer_load_dwordx4 v13, s[12:15], s64 offen offset:256 nt lds
  s_add_u32 m0, s53, 125056
  s_nop 0
  buffer_load_dwordx4 v14, s[12:15], s64 offen offset:256 nt lds
  s_add_u32 m0, s53, 126080
  s_nop 0
  buffer_load_dwordx4 v15, s[12:15], s64 offen offset:256 nt lds
  s_bfe_u32 s48, s52, 0x40010
  s_mul_i32 s82, s48, 786432
  s_add_u32 s82, s82, s50
  s_lshl_b32 s83, s48, 7
  s_add_u32 s83, s83, s49
  s_waitcnt vmcnt(14)
  s_barrier
  s_add_u32 m0, s54, 57472
  s_nop 0
  buffer_load_dwordx4 v16, s[8:11], s82 offen  lds
  s_add_u32 m0, s54, 58368
  s_nop 0
  buffer_load_dwordx4 v16, s[8:11], s82 offen offset:128  lds
  s_add_u32 m0, s54, 59264
  s_nop 0
  buffer_load_dwordx4 v16, s[8:11], s82 offen offset:256  lds
  s_add_u32 m0, s54, 69824
  s_nop 0
  buffer_load_dwordx4 v17, s[8:11], s82 offen  lds
  s_add_u32 m0, s54, 70720
  s_nop 0
  buffer_load_dwordx4 v17, s[8:11], s82 offen offset:128  lds
  s_add_u32 m0, s54, 71616
  s_nop 0
  buffer_load_dwordx4 v17, s[8:11], s82 offen offset:256  lds
  s_add_u32 m0, s53, 41088
  s_nop 0
  buffer_load_dwordx4 v8, s[4:7], s83 offen  lds
  s_add_u32 m0, s53, 42112
  s_nop 0
  buffer_load_dwordx4 v9, s[4:7], s83 offen  lds
  s_add_u32 m0, s53, 43136
  s_nop 0
  buffer_load_dwordx4 v10, s[4:7], s83 offen  lds
  s_add_u32 m0, s53, 44160
  s_nop 0
  buffer_load_dwordx4 v11, s[4:7], s83 offen  lds
  s_bfe_u32 s48, s52, 0x40014
  s_mul_i32 s76, s48, 786432
  s_add_u32 s76, s76, s50
  s_lshl_b32 s77, s48, 7
  s_add_u32 s77, s77, s49
  s_waitcnt vmcnt(14)
  s_barrier
  s_add_u32 m0, s54, 98560
  s_nop 0
  buffer_load_dwordx4 v16, s[8:11], s76 offen  lds
  s_add_u32 m0, s54, 99456
  s_nop 0
  buffer_load_dwordx4 v16, s[8:11], s76 offen offset:128  lds
  s_add_u32 m0, s54, 100352
  s_nop 0
  buffer_load_dwordx4 v16, s[8:11], s76 offen offset:256  lds
  s_add_u32 m0, s54, 110912
  s_nop 0
  buffer_load_dwordx4 v17, s[8:11], s76 offen  lds
  s_add_u32 m0, s54, 111808
  s_nop 0
  buffer_load_dwordx4 v17, s[8:11], s76 offen offset:128  lds
  s_add_u32 m0, s54, 112704
  s_nop 0
  buffer_load_dwordx4 v17, s[8:11], s76 offen offset:256  lds
  s_add_u32 m0, s53, 82176
  s_nop 0
  buffer_load_dwordx4 v8, s[4:7], s77 offen  lds
  s_add_u32 m0, s53, 83200
  s_nop 0
  buffer_load_dwordx4 v9, s[4:7], s77 offen  lds
  s_add_u32 m0, s53, 84224
  s_nop 0
  buffer_load_dwordx4 v10, s[4:7], s77 offen  lds
  s_add_u32 m0, s53, 85248
  s_nop 0
  buffer_load_dwordx4 v11, s[4:7], s77 offen  lds
  s_bfe_u32 s48, s51, 0x40000
  s_mul_i32 s80, s48, 81920
  s_add_u32 s79, s80, s60
  s_add_u32 s80, s80, s61
  s_lshl_b32 s81, s48, 7
  s_mul_i32 s48, s48, 11
  s_lshr_b32 s48, s48, 5
  s_mul_i32 s48, s48, 11904
  s_add_u32 s81, s81, s65
  s_add_u32 s81, s81, s48
  s_waitcnt vmcnt(10)
  s_barrier
  s_add_u32 m0, s66, 16384
  s_nop 0
  buffer_load_dwordx4 v18, s[20:23], s79 offen  lds
  s_add_u32 m0, s66, 17280
  s_nop 0
  buffer_load_dwordx4 v18, s[20:23], s79 offen offset:128  lds
  s_add_u32 m0, s66, 24640
  s_nop 0
  buffer_load_dwordx4 v19, s[20:23], s79 offen  lds
  s_add_u32 m0, s66, 25536
  s_nop 0
  buffer_load_dwordx4 v19, s[20:23], s79 offen offset:128  lds
  s_add_u32 m0, s55, 33024
  s_nop 0
  buffer_load_dwordx4 v20, s[20:23], s80 offen  lds
  s_add_u32 m0, s53, 0
  s_nop 0
  buffer_load_dwordx4 v12, s[16:19], s81 offen  lds
  s_add_u32 m0, s53, 1024
  s_nop 0
  buffer_load_dwordx4 v13, s[16:19], s81 offen  lds
  s_add_u32 m0, s53, 2048
  s_nop 0
  buffer_load_dwordx4 v14, s[16:19], s81 offen  lds
  s_add_u32 m0, s53, 3072
  s_nop 0
  buffer_load_dwordx4 v15, s[16:19], s81 offen  lds
  s_bfe_u32 s48, s51, 0x40004
  s_mul_i32 s83, s48, 81920
  s_add_u32 s82, s83, s60
  s_add_u32 s83, s83, s61
  s_lshl_b32 s84, s48, 7
  s_mul_i32 s48, s48, 11
  s_lshr_b32 s48, s48, 5
  s_mul_i32 s48, s48, 11904
  s_add_u32 s84, s84, s65
  s_add_u32 s84, s84, s48
  s_waitcnt vmcnt(9)
  s_barrier
  s_bfe_u32 s48, s51, 0x40008
  s_mul_i32 s77, s48, 81920
  s_add_u32 s76, s77, s60
  s_add_u32 s77, s77, s61
  s_lshl_b32 s78, s48, 7
  s_mul_i32 s48, s48, 11
  s_lshr_b32 s48, s48, 5
  s_mul_i32 s48, s48, 11904
  s_add_u32 s78, s78, s65
  s_add_u32 s78, s78, s48
  s_bitcmp1_b32 s57, 11
  s_cbranch_scc0 L_lb10
  s_add_u32 m0, s66, 57472
  s_nop 0
  buffer_load_dwordx4 v18, s[20:23], s82 offen  lds
  s_add_u32 m0, s66, 58368
  s_nop 0
  buffer_load_dwordx4 v18, s[20:23], s82 offen offset:128  lds
  s_add_u32 m0, s66, 65728
  s_nop 0
  buffer_load_dwordx4 v19, s[20:23], s82 offen  lds
  s_add_u32 m0, s66, 66624
  s_nop 0
  buffer_load_dwordx4 v19, s[20:23], s82 offen offset:128  lds
  s_add_u32 m0, s55, 74112
  s_nop 0
  buffer_load_dwordx4 v20, s[20:23], s83 offen  lds
  s_add_u32 m0, s53, 41088
  s_nop 0
  buffer_load_dwordx4 v12, s[16:19], s84 offen  lds
  s_waitcnt vmcnt(15)
  s_branch L_lc10
L_lb10:
  s_waitcnt vmcnt(9)
L_lc10:
  s_barrier
  s_bitcmp1_b32 s57, 11
  s_cbranch_scc1 L_la11
  s_add_u32 m0, s66, 57472
  s_nop 0
  buffer_load_dwordx4 v18, s[20:23], s82 offen  lds
  s_add_u32 m0, s66, 58368
  s_nop 0
  buffer_load_dwordx4 v18, s[20:23], s82 offen offset:128  lds
  s_add_u32 m0, s66, 65728
  s_nop 0
  buffer_load_dwordx4 v19, s[20:23], s82 offen  lds
  s_add_u32 m0, s66, 66624
  s_nop 0
  buffer_load_dwordx4 v19, s[20:23], s82 offen offset:128  lds
  s_add_u32 m0, s55, 74112
  s_nop 0
  buffer_load_dwordx4 v20, s[20:23], s83 offen  lds
  s_add_u32 m0, s53, 41088
  s_nop 0
  buffer_load_dwordx4 v12, s[16:19], s84 offen  lds
L_la11:
  s_add_u32 m0, s53, 42112
  s_nop 0
  buffer_load_dwordx4 v13, s[16:19], s84 offen  lds
  s_add_u32 m0, s53, 43136
  s_nop 0
  buffer_load_dwordx4 v14, s[16:19], s84 offen  lds
  s_add_u32 m0, s53, 44160
  s_nop 0
  buffer_load_dwordx4 v15, s[16:19], s84 offen  lds
  s_bfe_u32 s48, s51, 0x4000c
  s_mul_i32 s80, s48, 81920
  s_add_u32 s79, s80, s60
  s_add_u32 s80, s80, s61
  s_lshl_b32 s81, s48, 7
  s_mul_i32 s48, s48, 11
  s_lshr_b32 s48, s48, 5
  s_mul_i32 s48, s48, 11904
  s_add_u32 s81, s81, s65
  s_add_u32 s81, s81, s48
  s_waitcnt vmcnt(9)
  s_barrier
  s_add_u32 m0, s66, 98560
  s_nop 0
  buffer_load_dwordx4 v18, s[20:23], s76 offen  lds
  s_add_u32 m0, s66, 99456
  s_nop 0
  buffer_load_dwordx4 v18, s[20:23], s76 offen offset:128  lds
  s_add_u32 m0, s66, 106816
  s_nop 0
  buffer_load_dwordx4 v19, s[20:23], s76 offen  lds
  s_add_u32 m0, s66, 107712
  s_nop 0
  buffer_load_dwordx4 v19, s[20:23], s76 offen offset:128  lds
  s_add_u32 m0, s55, 115200
  s_nop 0
  buffer_load_dwordx4 v20, s[20:23], s77 offen  lds
  s_add_u32 m0, s53, 82176
  s_nop 0
  buffer_load_dwordx4 v12, s[16:19], s78 offen  lds
  s_add_u32 m0, s53, 83200
  s_nop 0
  buffer_load_dwordx4 v13, s[16:19], s78 offen  lds
  s_add_u32 m0, s53, 84224
  s_nop 0
  buffer_load_dwordx4 v14, s[16:19], s78 offen  lds
  s_add_u32 m0, s53, 85248
  s_nop 0
  buffer_load_dwordx4 v15, s[16:19], s78 offen  lds
  s_bfe_u32 s48, s51, 0x40010
  s_mul_i32 s83, s48, 81920
  s_add_u32 s82, s83, s60
  s_add_u32 s83, s83, s61
  s_lshl_b32 s84, s48, 7
  s_mul_i32 s48, s48, 11
  s_lshr_b32 s48, s48, 5
  s_mul_i32 s48, s48, 11904
  s_add_u32 s84, s84, s65
  s_add_u32 s84, s84, s48
  s_bitcmp1_b32 s57, 13
  s_cbranch_scc0 L_lb12
  s_add_u32 m0, s66, 139648
  s_nop 0
  buffer_load_dwordx4 v18, s[20:23], s79 offen  lds
  s_add_u32 m0, s66, 140544
  s_nop 0
  buffer_load_dwordx4 v18, s[20:23], s79 offen offset:128  lds
  s_add_u32 m0, s66, 147904
  s_nop 0
  buffer_load_dwordx4 v19, s[20:23], s79 offen  lds
  s_add_u32 m0, s66, 148800
  s_nop 0
  buffer_load_dwordx4 v19, s[20:23], s79 offen offset:128  lds
  s_add_u32 m0, s55, 156288
  s_nop 0
  buffer_load_dwordx4 v20, s[20:23], s80 offen  lds
  s_add_u32 m0, s53, 123264
  s_nop 0
  buffer_load_dwordx4 v12, s[16:19], s81 offen  lds
  s_waitcnt vmcnt(15)
  s_branch L_lc12
L_lb12:
  s_waitcnt vmcnt(9)
L_lc12:
  s_barrier
  s_bitcmp1_b32 s57, 13
  s_cbranch_scc1 L_la13
  s_add_u32 m0, s66, 139648
  s_nop 0
  buffer_load_dwordx4 v18, s[20:23], s79 offen  lds
  s_add_u32 m0, s66, 140544
  s_nop 0
  buffer_load_dwordx4 v18, s[20:23], s79 offen offset:128  lds
  s_add_u32 m0, s66, 147904
  s_nop 0
  buffer_load_dwordx4 v19, s[20:23], s79 offen  lds
  s_add_u32 m0, s66, 148800
  s_nop 0
  buffer_load_dwordx4 v19, s[20:23], s79 offen offset:128  lds
  s_add_u32 m0, s55, 156288
  s_nop 0
  buffer_load_dwordx4 v20, s[20:23], s80 offen  lds
  s_add_u32 m0, s53, 123264
  s_nop 0
  buffer_load_dwordx4 v12, s[16:19], s81 offen  lds
L_la13:
  s_add_u32 m0, s53, 124288
  s_nop 0
  buffer_load_dwordx4 v13, s[16:19], s81 offen  lds
  s_add_u32 m0, s53, 125312
  s_nop 0
  buffer_load_dwordx4 v14, s[16:19], s81 offen  lds
  s_add_u32 m0, s53, 126336
  s_nop 0
  buffer_load_dwordx4 v15, s[16:19], s81 offen  lds
  s_bfe_u32 s48, s51, 0x40014
  s_mul_i32 s77, s48, 81920
  s_add_u32 s76, s77, s60
  s_add_u32 s77, s77, s61
  s_lshl_b32 s78, s48, 7
  s_mul_i32 s48, s48, 11
  s_lshr_b32 s48, s48, 5
  s_mul_i32 s48, s48, 11904
  s_add_u32 s78, s78, s65
  s_add_u32 s78, s78, s48
  s_bitcmp1_b32 s57, 14
  s_cbranch_scc0 L_lb13
  s_add_u32 m0, s66, 16384
  s_nop 0
  buffer_load_dwordx4 v18, s[20:23], s82 offen  lds
  s_add_u32 m0, s66, 17280
  s_nop 0
  buffer_load_dwordx4 v18, s[20:23], s82 offen offset:128  lds
  s_add_u32 m0, s66, 24640
  s_nop 0
  buffer_load_dwordx4 v19, s[20:23], s82 offen  lds
  s_add_u32 m0, s66, 25536
  s_nop 0
  buffer_load_dwordx4 v19, s[20:23], s82 offen offset:128  lds
  s_add_u32 m0, s55, 33024
  s_nop 0
  buffer_load_dwordx4 v20, s[20:23], s83 offen  lds
  s_add_u32 m0, s53, 0
  s_nop 0
  buffer_load_dwordx4 v12, s[16:19], s84 offen  lds
  s_waitcnt vmcnt(15)
  s_branch L_lc13
L_lb13:
  s_waitcnt vmcnt(9)
L_lc13:
  s_barrier
  s_bitcmp1_b32 s57, 14
  s_cbranch_scc1 L_la14
  s_add_u32 m0, s66, 16384
  s_nop 0
  buffer_load_dwordx4 v18, s[20:23], s82 offen  lds
  s_add_u32 m0, s66, 17280
  s_nop 0
  buffer_load_dwordx4 v18, s[20:23], s82 offen offset:128  lds
  s_add_u32 m0, s66, 24640
  s_nop 0
  buffer_load_dwordx4 v19, s[20:23], s82 offen  lds
  s_add_u32 m0, s66, 25536
  s_nop 0
  buffer_load_dwordx4 v19, s[20:23], s82 offen offset:128  lds
  s_add_u32 m0, s55, 33024
  s_nop 0
  buffer_load_dwordx4 v20, s[20:23], s83 offen  lds
  s_add_u32 m0, s53, 0
  s_nop 0
  buffer_load_dwordx4 v12, s[16:19], s84 offen  lds
L_la14:
  s_add_u32 m0, s53, 1024
  s_nop 0
  buffer_load_dwordx4 v13, s[16:19], s84 offen  lds
  s_add_u32 m0, s53, 2048
  s_nop 0
  buffer_load_dwordx4 v14, s[16:19], s84 offen  lds
  s_add_u32 m0, s53, 3072
  s_nop 0
  buffer_load_dwordx4 v15, s[16:19], s84 offen  lds
  s_bfe_u32 s48, s51, 0x40018
  s_mul_i32 s80, s48, 81920
  s_add_u32 s79, s80, s60
  s_add_u32 s80, s80, s61
  s_lshl_b32 s81, s48, 7
  s_mul_i32 s48, s48, 11
  s_lshr_b32 s48, s48, 5
  s_mul_i32 s48, s48, 11904
  s_add_u32 s81, s81, s65
  s_add_u32 s81, s81, s48
  s_waitcnt vmcnt(9)
  s_barrier
  s_add_u32 m0, s66, 57472
  s_nop 0
  buffer_load_dwordx4 v18, s[20:23], s76 offen  lds
  s_add_u32 m0, s66, 58368
  s_nop 0
  buffer_load_dwordx4 v18, s[20:23], s76 offen offset:128  lds
  s_add_u32 m0, s66, 65728
  s_nop 0
  buffer_load_dwordx4 v19, s[20:23], s76 offen  lds
  s_add_u32 m0, s66, 66624
  s_nop 0
  buffer_load_dwordx4 v19, s[20:23], s76 offen offset:128  lds
  s_add_u32 m0, s55, 74112
  s_nop 0
  buffer_load_dwordx4 v20, s[20:23], s77 offen  lds
  s_add_u32 m0, s53, 41088
  s_nop 0
  buffer_load_dwordx4 v12, s[16:19], s78 offen  lds
  s_add_u32 m0, s53, 42112
  s_nop 0
  buffer_load_dwordx4 v13, s[16:19], s78 offen  lds
  s_add_u32 m0, s53, 43136
  s_nop 0
  buffer_load_dwordx4 v14, s[16:19], s78 offen  lds
  s_add_u32 m0, s53, 44160
  s_nop 0
  buffer_load_dwordx4 v15, s[16:19], s78 offen  lds
  s_bfe_u32 s48, s51, 0x4001c
  s_mul_i32 s83, s48, 81920
  s_add_u32 s82, s83, s60
  s_add_u32 s83, s83, s61
  s_lshl_b32 s84, s48, 7
  s_mul_i32 s48, s48, 11
  s_lshr_b32 s48, s48, 5
  s_mul_i32 s48, s48, 11904
  s_add_u32 s84, s84, s65
  s_add_u32 s84, s84, s48
  s_bitcmp1_b32 s57, 16
  s_cbranch_scc0 L_lb15
  s_add_u32 m0, s66, 98560
  s_nop 0
  buffer_load_dwordx4 v18, s[20:23], s79 offen  lds
  s_add_u32 m0, s66, 99456
  s_nop 0
  buffer_load_dwordx4 v18, s[20:23], s79 offen offset:128  lds
  s_add_u32 m0, s66, 106816
  s_nop 0
  buffer_load_dwordx4 v19, s[20:23], s79 offen  lds
  s_add_u32 m0, s66, 107712
  s_nop 0
  buffer_load_dwordx4 v19, s[20:23], s79 offen offset:128  lds
  s_add_u32 m0, s55, 115200
  s_nop 0
  buffer_load_dwordx4 v20, s[20:23], s80 offen  lds
  s_add_u32 m0, s53, 82176
  s_nop 0
  buffer_load_dwordx4 v12, s[16:19], s81 offen  lds
  s_waitcnt vmcnt(15)
  s_branch L_lc15
L_lb15:
  s_waitcnt vmcnt(9)
L_lc15:
  s_barrier
  s_bitcmp1_b32 s57, 16
  s_cbranch_scc1 L_la16
  s_add_u32 m0, s66, 98560
  s_nop 0
  buffer_load_dwordx4 v18, s[20:23], s79 offen  lds
  s_add_u32 m0, s66, 99456
  s_nop 0
  buffer_load_dwordx4 v18, s[20:23], s79 offen offset:128  lds
  s_add_u32 m0, s66, 106816
  s_nop 0
  buffer_load_dwordx4 v19, s[20:23], s79 offen  lds
  s_add_u32 m0, s66, 107712
  s_nop 0
  buffer_load_dwordx4 v19, s[20:23], s79 offen offset:128  lds
  s_add_u32 m0, s55, 115200
  s_nop 0
  buffer_load_dwordx4 v20, s[20:23], s80 offen  lds
  s_add_u32 m0, s53, 82176
  s_nop 0
  buffer_load_dwordx4 v12, s[16:19], s81 offen  lds
L_la16:
  s_add_u32 m0, s53, 83200
  s_nop 0
  buffer_load_dwordx4 v13, s[16:19], s81 offen  lds
  s_add_u32 m0, s53, 84224
  s_nop 0
  buffer_load_dwordx4 v14, s[16:19], s81 offen  lds
  s_add_u32 m0, s53, 85248
  s_nop 0
  buffer_load_dwordx4 v15, s[16:19], s81 offen  lds
  s_bfe_u32 s48, s52, 0x40000
  s_mul_i32 s77, s48, 81920
  s_add_u32 s76, s77, s60
  s_add_u32 s77, s77, s61
  s_lshl_b32 s78, s48, 7
  s_mul_i32 s48, s48, 11
  s_lshr_b32 s48, s48, 5
  s_mul_i32 s48, s48, 11904
  s_add_u32 s78, s78, s65
  s_add_u32 s78, s78, s48
  s_bitcmp1_b32 s57, 17
  s_cbranch_scc0 L_lb16
  s_add_u32 m0, s66, 139648
  s_nop 0
  buffer_load_dwordx4 v18, s[20:23], s82 offen  lds
  s_add_u32 m0, s66, 140544
  s_nop 0
  buffer_load_dwordx4 v18, s[20:23], s82 offen offset:128  lds
  s_add_u32 m0, s66, 147904
  s_nop 0
  buffer_load_dwordx4 v19, s[20:23], s82 offen  lds
  s_add_u32 m0, s66, 148800
  s_nop 0
  buffer_load_dwordx4 v19, s[20:23], s82 offen offset:128  lds
  s_add_u32 m0, s55, 156288
  s_nop 0
  buffer_load_dwordx4 v20, s[20:23], s83 offen  lds
  s_add_u32 m0, s53, 123264
  s_nop 0
  buffer_load_dwordx4 v12, s[16:19], s84 offen  lds
  s_waitcnt vmcnt(15)
  s_branch L_lc16
L_lb16:
  s_waitcnt vmcnt(9)
L_lc16:
  s_barrier
  s_bitcmp1_b32 s57, 17
  s_cbranch_scc1 L_la17
  s_add_u32 m0, s66, 139648
  s_nop 0
  buffer_load_dwordx4 v18, s[20:23], s82 offen  lds
  s_add_u32 m0, s66, 140544
  s_nop 0
  buffer_load_dwordx4 v18, s[20:23], s82 offen offset:128  lds
  s_add_u32 m0, s66, 147904
  s_nop 0
  buffer_load_dwordx4 v19, s[20:23], s82 offen  lds
  s_add_u32 m0, s66, 148800
  s_nop 0
  buffer_load_dwordx4 v19, s[20:23], s82 offen offset:128  lds
  s_add_u32 m0, s55, 156288
  s_nop 0
  buffer_load_dwordx4 v20, s[20:23], s83 offen  lds
  s_add_u32 m0, s53, 123264
  s_nop 0
  buffer_load_dwordx4 v12, s[16:19], s84 offen  lds
L_la17:
  s_add_u32 m0, s53, 124288
  s_nop 0
  buffer_load_dwordx4 v13, s[16:19], s84 offen  lds
  s_add_u32 m0, s53, 125312
  s_nop 0
  buffer_load_dwordx4 v14, s[16:19], s84 offen  lds
  s_add_u32 m0, s53, 126336
  s_nop 0
  buffer_load_dwordx4 v15, s[16:19], s84 offen  lds
  s_bfe_u32 s48, s52, 0x40004
  s_mul_i32 s80, s48, 81920
  s_add_u32 s79, s80, s60
  s_add_u32 s80, s80, s61
  s_lshl_b32 s81, s48, 7
  s_mul_i32 s48, s48, 11
  s_lshr_b32 s48, s48, 5
  s_mul_i32 s48, s48, 11904
  s_add_u32 s81, s81, s65
  s_add_u32 s81, s81, s48
  s_waitcnt vmcnt(9)
  s_barrier
  s_add_u32 m0, s66, 16384
  s_nop 0
  buffer_load_dwordx4 v18, s[20:23], s76 offen  lds
  s_add_u32 m0, s66, 17280
  s_nop 0
  buffer_load_dwordx4 v18, s[20:23], s76 offen offset:128  lds
  s_add_u32 m0, s66, 24640
  s_nop 0
  buffer_load_dwordx4 v19, s[20:23], s76 offen  lds
  s_add_u32 m0, s66, 25536
  s_nop 0
  buffer_load_dwordx4 v19, s[20:23], s76 offen offset:128  lds
  s_add_u32 m0, s55, 33024
  s_nop 0
  buffer_load_dwordx4 v20, s[20:23], s77 offen  lds
  s_add_u32 m0, s53, 0
  s_nop 0
  buffer_load_dwordx4 v12, s[16:19], s78 offen  lds
  s_add_u32 m0, s53, 1024
  s_nop 0
  buffer_load_dwordx4 v13, s[16:19], s78 offen  lds
  s_add_u32 m0, s53, 2048
  s_nop 0
  buffer_load_dwordx4 v14, s[16:19], s78 offen  lds
  s_add_u32 m0, s53, 3072
  s_nop 0
  buffer_load_dwordx4 v15, s[16:19], s78 offen  lds
  s_bfe_u32 s48, s52, 0x40008
  s_mul_i32 s83, s48, 81920
  s_add_u32 s82, s83, s60
  s_add_u32 s83, s83, s61
  s_lshl_b32 s84, s48, 7
  s_mul_i32 s48, s48, 11
  s_lshr_b32 s48, s48, 5
  s_mul_i32 s48, s48, 11904
  s_add_u32 s84, s84, s65
  s_add_u32 s84, s84, s48
  s_bitcmp1_b32 s57, 19
  s_cbranch_scc0 L_lb18
  s_add_u32 m0, s66, 57472
  s_nop 0
  buffer_load_dwordx4 v18, s[20:23], s79 offen  lds
  s_add_u32 m0, s66, 58368
  s_nop 0
  buffer_load_dwordx4 v18, s[20:23], s79 offen offset:128  lds
  s_add_u32 m0, s66, 65728
  s_nop 0
  buffer_load_dwordx4 v19, s[20:23], s79 offen  lds
  s_add_u32 m0, s66, 66624
  s_nop 0
  buffer_load_dwordx4 v19, s[20:23], s79 offen offset:128  lds
  s_add_u32 m0, s55, 74112
  s_nop 0
  buffer_load_dwordx4 v20, s[20:23], s80 offen  lds
  s_add_u32 m0, s53, 41088
  s_nop 0
  buffer_load_dwordx4 v12, s[16:19], s81 offen  lds
  s_waitcnt vmcnt(15)
  s_branch L_lc18
L_lb18:
  s_waitcnt vmcnt(9)
L_lc18:
  s_barrier
  s_bitcmp1_b32 s57, 19
  s_cbranch_scc1 L_la19
  s_add_u32 m0, s66, 57472
  s_nop 0
  buffer_load_dwordx4 v18, s[20:23], s79 offen  lds
  s_add_u32 m0, s66, 58368
  s_nop 0
  buffer_load_dwordx4 v18, s[20:23], s79 offen offset:128  lds
  s_add_u32 m0, s66, 65728
  s_nop 0
  buffer_load_dwordx4 v19, s[20:23], s79 offen  lds
  s_add_u32 m0, s66, 66624
  s_nop 0
  buffer_load_dwordx4 v19, s[20:23], s79 offen offset:128  lds
  s_add_u32 m0, s55, 74112
  s_nop 0
  buffer_load_dwordx4 v20, s[20:23], s80 offen  lds
  s_add_u32 m0, s53, 41088
  s_nop 0
  buffer_load_dwordx4 v12, s[16:19], s81 offen  lds
L_la19:
  s_add_u32 m0, s53, 42112
  s_nop 0
  buffer_load_dwordx4 v13, s[16:19], s81 offen  lds
  s_add_u32 m0, s53, 43136
  s_nop 0
  buffer_load_dwordx4 v14, s[16:19], s81 offen  lds
  s_add_u32 m0, s53, 44160
  s_nop 0
  buffer_load_dwordx4 v15, s[16:19], s81 offen  lds
  s_bfe_u32 s48, s52, 0x4000c
  s_mul_i32 s77, s48, 81920
  s_add_u32 s76, s77, s60
  s_add_u32 s77, s77, s61
  s_lshl_b32 s78, s48, 7
  s_mul_i32 s48, s48, 11
  s_lshr_b32 s48, s48, 5
  s_mul_i32 s48, s48, 11904
  s_add_u32 s78, s78, s65
  s_add_u32 s78, s78, s48
  s_waitcnt vmcnt(9)
  s_barrier
  s_add_u32 m0, s66, 98560
  s_nop 0
  buffer_load_dwordx4 v18, s[20:23], s82 offen  lds
  s_add_u32 m0, s66, 99456
  s_nop 0
  buffer_load_dwordx4 v18, s[20:23], s82 offen offset:128  lds
  s_add_u32 m0, s66, 106816
  s_nop 0
  buffer_load_dwordx4 v19, s[20:23], s82 offen  lds
  s_add_u32 m0, s66, 107712
  s_nop 0
  buffer_load_dwordx4 v19, s[20:23], s82 offen offset:128  lds
  s_add_u32 m0, s55, 115200
  s_nop 0
  buffer_load_dwordx4 v20, s[20:23], s83 offen  lds
  s_add_u32 m0, s53, 82176
  s_nop 0
  buffer_load_dwordx4 v12, s[16:19], s84 offen  lds
  s_add_u32 m0, s53, 83200
  s_nop 0
  buffer_load_dwordx4 v13, s[16:19], s84 offen  lds
  s_add_u32 m0, s53, 84224
  s_nop 0
  buffer_load_dwordx4 v14, s[16:19], s84 offen  lds
  s_add_u32 m0, s53, 85248
  s_nop 0
  buffer_load_dwordx4 v15, s[16:19], s84 offen  lds
  s_waitcnt vmcnt(9)
  s_barrier
  s_add_u32 m0, s66, 139648
  s_nop 0
  buffer_load_dwordx4 v18, s[20:23], s76 offen  lds
  s_add_u32 m0, s66, 140544
  s_nop 0
  buffer_load_dwordx4 v18, s[20:23], s76 offen offset:128  lds
  s_add_u32 m0, s66, 147904
  s_nop 0
  buffer_load_dwordx4 v19, s[20:23], s76 offen  lds
  s_add_u32 m0, s66, 148800
  s_nop 0
  buffer_load_dwordx4 v19, s[20:23], s76 offen offset:128  lds
  s_add_u32 m0, s55, 156288
  s_nop 0
  buffer_load_dwordx4 v20, s[20:23], s77 offen  lds
  s_add_u32 m0, s53, 123264
  s_nop 0
  buffer_load_dwordx4 v12, s[16:19], s78 offen  lds
  s_add_u32 m0, s53, 124288
  s_nop 0
  buffer_load_dwordx4 v13, s[16:19], s78 offen  lds
  s_add_u32 m0, s53, 125312
  s_nop 0
  buffer_load_dwordx4 v14, s[16:19], s78 offen  lds
  s_add_u32 m0, s53, 126336
  s_nop 0
  buffer_load_dwordx4 v15, s[16:19], s78 offen  lds
  s_waitcnt vmcnt(9)
  s_barrier
  s_waitcnt vmcnt(0)
  s_barrier
L_ldone:
  s_mov_b32 s60, s41
  s_lshl_b32 s44, s33, 2
  s_add_u32 s44, s44, s40
  s_mul_i32 s44, s44, 327680
  s_mul_i32 s45, s39, 40960
  s_add_u32 s44, s44, s45
  s_lshl_b32 s45, s60, 10
  s_add_u32 s44, s44, s45
  s_add_u32 s61, s44, 2097152
  s_lshl_b32 s46, s37, 3
  s_add_u32 s46, s46, s39
  s_mul_i32 s46, s46, 40960
  s_mul_i32 s45, s36, 1280
  s_add_u32 s46, s46, s45
  s_mul_i32 s45, s40, 320
  s_add_u32 s46, s46, s45
  s_and_b32 s45, s40, 1
  s_add_u32 s45, s45, s60
  s_cmp_eq_u32 s45, 5
  s_cselect_b32 s45, 0, s45
  s_lshl_b32 s45, s45, 6
  s_add_u32 s62, s46, s45
  s_mov_b32 s24, s86
  s_mov_b32 s25, s87
  s_mov_b32 s26, 1310720
  s_mov_b32 s27, 0x00020000
  v_lshlrev_b32 v2, 4, v0
  v_and_b32 v4, 15, v0
  v_mul_u32_u24 v4, 2560, v4
  v_bfe_u32 v5, v0, 4, 1
  v_lshl_add_u32 v4, v5, 5, v4
  v_lshrrev_b32 v5, 5, v0
  v_lshl_add_u32 v4, v5, 4, v4
  s_lshl_b32 s45, s60, 1
  s_and_b32 s46, s39, 1
  s_add_u32 s45, s45, s46
  s_lshl_b32 s45, s45, 10
  v_add_u32 v6, s45, v2
  s_add_u32 s45, s39, 1
  s_and_b32 s45, s45, 7
  s_mul_i32 s45, s45, 5120
  s_add_u32 s77, s61, s45
  s_add_u32 s45, s39, 2
  s_and_b32 s45, s45, 7
  s_mul_i32 s45, s45, 5120
  s_add_u32 s78, s61, s45
  s_add_u32 s45, s39, 3
  s_and_b32 s45, s45, 7
  s_mul_i32 s45, s45, 5120
  s_add_u32 s79, s61, s45
  s_add_u32 s45, s39, 4
  s_and_b32 s45, s45, 7
  s_mul_i32 s45, s45, 5120
  s_add_u32 s80, s61, s45
  s_add_u32 s45, s39, 5
  s_and_b32 s45, s45, 7
  s_mul_i32 s45, s45, 5120
  s_add_u32 s81, s61, s45
  s_add_u32 s45, s39, 6
  s_and_b32 s45, s45, 7
  s_mul_i32 s45, s45, 5120
  s_add_u32 s82, s61, s45
  s_add_u32 s45, s39, 7
  s_and_b32 s45, s45, 7
  s_mul_i32 s45, s45, 5120
  s_add_u32 s83, s61, s45
  v_lshrrev_b32 v7, 2, v0
  v_min_u32 v7, 6, v7
  v_add_u32 v7, s39, v7
  v_add_u32 v7, 1, v7
  v_and_b32 v7, 7, v7
  v_mul_u32_u24 v7, 5120, v7
  v_and_b32 v5, 3, v0
  v_lshl_add_u32 v7, v5, 4, v7
  v_and_b32 v5, 3, v0
  v_lshlrev_b32 v5, 2, v5
  v_lshrrev_b32 v5, v5, s32
  v_lshrrev_b32 v52, 0, v5
  v_and_b32 v52, 0x10001, v52
  v_lshl_or_b32 v52, v52, 15, v52
  v_lshrrev_b32 v53, 1, v5
  v_and_b32 v53, 0x10001, v53
  v_lshl_or_b32 v53, v53, 15, v53
  v_lshrrev_b32 v54, 2, v5
  v_and_b32 v54, 0x10001, v54
  v_lshl_or_b32 v54, v54, 15, v54
  v_lshrrev_b32 v55, 3, v5
  v_and_b32 v55, 0x10001, v55
  v_lshl_or_b32 v55, v55, 15, v55
  s_mov_b32 s58, 0x10001
  v_mov_b32 v3, 0xffff0000
  s_mov_b32 s47, 0x10000
  s_barrier
L_reduce:
  s_mov_b32 s70, 200000
  ds_read_b128 v[16:19], v6
  s_mov_b32 s71, 0xfe
  s_cmp_eq_u32 s60, 4
  s_waitcnt lgkmcnt(0)
  v_lshl_or_b32 v100, v16, 16, s47
  v_and_or_b32 v101, v16, v3, s47
  v_lshl_or_b32 v102, v17, 16, s47
  v_and_or_b32 v103, v17, v3, s47
  v_lshl_or_b32 v104, v18, 16, s47
  v_and_or_b32 v105, v18, v3, s47
  v_lshl_or_b32 v106, v19, 16, s47
  v_and_or_b32 v107, v19, v3, s47
  s_cbranch_scc1 L_rseen
  buffer_load_dwordx4 v[20:23], v7, s[28:31], s61 offen offset:960 sc1
L_rwatch:
  s_waitcnt vmcnt(0)
  v_xor_b32 v5, v20, v52
  v_bitop3_b32 v5, v5, v21, v53 bitop3:0xf6
  v_bitop3_b32 v5, v5, v22, v54 bitop3:0xf6
  v_bitop3_b32 v5, v5, v23, v55 bitop3:0xf6
  v_and_b32 v5, s58, v5
  v_cmp_ne_u32 vcc, 0, v5
  s_cbranch_vccz L_rseen
  s_sub_u32 s70, s70, 1
  s_cmp_eq_u32 s70, 0
  s_cbranch_scc1 L_exit
  buffer_load_dwordx4 v[20:23], v7, s[28:31], s61 offen offset:960 sc1
  s_branch L_rwatch
L_rseen:
  s_cmp_lg_u32 s60, 4
  s_cbranch_scc1 L_rfirst
  s_barrier
L_rfirst:
  buffer_load_dwordx4 v[20:23], v2, s[28:31], s77 offen sc1
  buffer_load_dwordx4 v[24:27], v2, s[28:31], s78 offen sc1
  buffer_load_dwordx4 v[28:31], v2, s[28:31], s79 offen sc1
  buffer_load_dwordx4 v[32:35], v2, s[28:31], s80 offen sc1
  buffer_load_dwordx4 v[36:39], v2, s[28:31], s81 offen sc1
  buffer_load_dwordx4 v[40:43], v2, s[28:31], s82 offen sc1
  buffer_load_dwordx4 v[44:47], v2, s[28:31], s83 offen sc1
  s_cbranch_scc0 L_rtake
  s_barrier
  s_branch L_rtake
L_rpoll:
  s_sub_u32 s70, s70, 1
  s_cmp_eq_u32 s70, 0
  s_cbranch_scc1 L_exit
  s_cmp_lg_u32 s71, 0xfe
  s_cbranch_scc1 L_rsome
  buffer_load_dwordx4 v[20:23], v2, s[28:31], s77 offen sc1
  buffer_load_dwordx4 v[24:27], v2, s[28:31], s78 offen sc1
  buffer_load_dwordx4 v[28:31], v2, s[28:31], s79 offen sc1
  buffer_load_dwordx4 v[32:35], v2, s[28:31], s80 offen sc1
  buffer_load_dwordx4 v[36:39], v2, s[28:31], s81 offen sc1
  buffer_load_dwordx4 v[40:43], v2, s[28:31], s82 offen sc1
  buffer_load_dwordx4 v[44:47], v2, s[28:31], s83 offen sc1
L_rtake:
  s_waitcnt vmcnt(6)
  v_xor_b32 v5, v20, v52
  v_bitop3_b32 v5, v5, v21, v53 bitop3:0xf6
  v_bitop3_b32 v5, v5, v22, v54 bitop3:0xf6
  v_bitop3_b32 v5, v5, v23, v55 bitop3:0xf6
  v_and_b32 v5, s58, v5
  v_cmp_ne_u32 vcc, 0, v5
  s_cbranch_vccnz L_ra1
  s_bitset0_b32 s71, 1
  v_lshl_or_b32 v108, v20, 16, s47
  v_and_or_b32 v109, v20, v3, s47
  v_lshl_or_b32 v110, v21, 16, s47
  v_and_or_b32 v111, v21, v3, s47
  v_lshl_or_b32 v112, v22, 16, s47
  v_and_or_b32 v113, v22, v3, s47
  v_lshl_or_b32 v114, v23, 16, s47
  v_and_or_b32 v115, v23, v3, s47
  v_pk_add_f32 v[100:101], v[100:101], v[108:109]
  v_pk_add_f32 v[102:103], v[102:103], v[110:111]
  v_pk_add_f32 v[104:105], v[104:105], v[112:113]
  v_pk_add_f32 v[106:107], v[106:107], v[114:115]
L_ra1:
  s_waitcnt vmcnt(5)
  v_xor_b32 v5, v24, v52
  v_bitop3_b32 v5, v5, v25, v53 bitop3:0xf6
  v_bitop3_b32 v5, v5, v26, v54 bitop3:0xf6
  v_bitop3_b32 v5, v5, v27, v55 bitop3:0xf6
  v_and_b32 v5, s58, v5
  v_cmp_ne_u32 vcc, 0, v5
  s_cbranch_vccnz L_ra2
  s_bitset0_b32 s71, 2
  v_lshl_or_b32 v108, v24, 16, s47
  v_and_or_b32 v109, v24, v3, s47
  v_lshl_or_b32 v110, v25, 16, s47
  v_and_or_b32 v111, v25, v3, s47
  v_lshl_or_b32 v112, v26, 16, s47
  v_and_or_b32 v113, v26, v3, s47
  v_lshl_or_b32 v114, v27, 16, s47
  v_and_or_b32 v115, v27, v3, s47
  v_pk_add_f32 v[100:101], v[100:101], v[108:109]
  v_pk_add_f32 v[102:103], v[102:103], v[110:111]
  v_pk_add_f32 v[104:105], v[104:105], v[112:113]
  v_pk_add_f32 v[106:107], v[106:107], v[114:115]
L_ra2:
  s_waitcnt vmcnt(4)
  v_xor_b32 v5, v28, v52
  v_bitop3_b32 v5, v5, v29, v53 bitop3:0xf6
  v_bitop3_b32 v5, v5, v30, v54 bitop3:0xf6
  v_bitop3_b32 v5, v5, v31, v55 bitop3:0xf6
  v_and_b32 v5, s58, v5
  v_cmp_ne_u32 vcc, 0, v5
  s_cbranch_vccnz L_ra3
  s_bitset0_b32 s71, 3
  v_lshl_or_b32 v108, v28, 16, s47
  v_and_or_b32 v109, v28, v3, s47
  v_lshl_or_b32 v110, v29, 16, s47
  v_and_or_b32 v111, v29, v3, s47
  v_lshl_or_b32 v112, v30, 16, s47
  v_and_or_b32 v113, v30, v3, s47
  v_lshl_or_b32 v114, v31, 16, s47
  v_and_or_b32 v115, v31, v3, s47
  v_pk_add_f32 v[100:101], v[100:101], v[108:109]
  v_pk_add_f32 v[102:103], v[102:103], v[110:111]
  v_pk_add_f32 v[104:105], v[104:105], v[112:113]
  v_pk_add_f32 v[106:107], v[106:107], v[114:115]
L_ra3:
  s_waitcnt vmcnt(3)
  v_xor_b32 v5, v32, v52
  v_bitop3_b32 v5, v5, v33, v53 bitop3:0xf6
  v_bitop3_b32 v5, v5, v34, v54 bitop3:0xf6
  v_bitop3_b32 v5, v5, v35, v55 bitop3:0xf6
  v_and_b32 v5, s58, v5
  v_cmp_ne_u32 vcc, 0, v5
  s_cbranch_vccnz L_ra4
  s_bitset0_b32 s71, 4
  v_lshl_or_b32 v108, v32, 16, s47
  v_and_or_b32 v109, v32, v3, s47
  v_lshl_or_b32 v110, v33, 16, s47
  v_and_or_b32 v111, v33, v3, s47
  v_lshl_or_b32 v112, v34, 16, s47
  v_and_or_b32 v113, v34, v3, s47
  v_lshl_or_b32 v114, v35, 16, s47
  v_and_or_b32 v115, v35, v3, s47
  v_pk_add_f32 v[100:101], v[100:101], v[108:109]
  v_pk_add_f32 v[102:103], v[102:103], v[110:111]
  v_pk_add_f32 v[104:105], v[104:105], v[112:113]
  v_pk_add_f32 v[106:107], v[106:107], v[114:115]
L_ra4:
  s_waitcnt vmcnt(2)
  v_xor_b32 v5, v36, v52
  v_bitop3_b32 v5, v5, v37, v53 bitop3:0xf6
  v_bitop3_b32 v5, v5, v38, v54 bitop3:0xf6
  v_bitop3_b32 v5, v5, v39, v55 bitop3:0xf6
  v_and_b32 v5, s58, v5
  v_cmp_ne_u32 vcc, 0, v5
  s_cbranch_vccnz L_ra5
  s_bitset0_b32 s71, 5
  v_lshl_or_b32 v108, v36, 16, s47
  v_and_or_b32 v109, v36, v3, s47
  v_lshl_or_b32 v110, v37, 16, s47
  v_and_or_b32 v111, v37, v3, s47
  v_lshl_or_b32 v112, v38, 16, s47
  v_and_or_b32 v113, v38, v3, s47
  v_lshl_or_b32 v114, v39, 16, s47
  v_and_or_b32 v115, v39, v3, s47
  v_pk_add_f32 v[100:101], v[100:101], v[108:109]
  v_pk_add_f32 v[102:103], v[102:103], v[110:111]
  v_pk_add_f32 v[104:105], v[104:105], v[112:113]
  v_pk_add_f32 v[106:107], v[106:107], v[114:115]
L_ra5:
  s_waitcnt vmcnt(1)
  v_xor_b32 v5, v40, v52
  v_bitop3_b32 v5, v5, v41, v53 bitop3:0xf6
  v_bitop3_b32 v5, v5, v42, v54 bitop3:0xf6
  v_bitop3_b32 v5, v5, v43, v55 bitop3:0xf6
  v_and_b32 v5, s58, v5
  v_cmp_ne_u32 vcc, 0, v5
  s_cbranch_vccnz L_ra6
  s_bitset0_b32 s71, 6
  v_lshl_or_b32 v108, v40, 16, s47
  v_and_or_b32 v109, v40, v3, s47
  v_lshl_or_b32 v110, v41, 16, s47
  v_and_or_b32 v111, v41, v3, s47
  v_lshl_or_b32 v112, v42, 16, s47
  v_and_or_b32 v113, v42, v3, s47
  v_lshl_or_b32 v114, v43, 16, s47
  v_and_or_b32 v115, v43, v3, s47
  v_pk_add_f32 v[100:101], v[100:101], v[108:109]
  v_pk_add_f32 v[102:103], v[102:103], v[110:111]
  v_pk_add_f32 v[104:105], v[104:105], v[112:113]
  v_pk_add_f32 v[106:107], v[106:107], v[114:115]
L_ra6:
  s_waitcnt vmcnt(0)
  v_xor_b32 v5, v44, v52
  v_bitop3_b32 v5, v5, v45, v53 bitop3:0xf6
  v_bitop3_b32 v5, v5, v46, v54 bitop3:0xf6
  v_bitop3_b32 v5, v5, v47, v55 bitop3:0xf6
  v_and_b32 v5, s58, v5
  v_cmp_ne_u32 vcc, 0, v5
  s_cbranch_vccnz L_ra7
  s_bitset0_b32 s71, 7
  v_lshl_or_b32 v108, v44, 16, s47
  v_and_or_b32 v109, v44, v3, s47
  v_lshl_or_b32 v110, v45, 16, s47
  v_and_or_b32 v111, v45, v3, s47
  v_lshl_or_b32 v112, v46, 16, s47
  v_and_or_b32 v113, v46, v3, s47
  v_lshl_or_b32 v114, v47, 16, s47
  v_and_or_b32 v115, v47, v3, s47
  v_pk_add_f32 v[100:101], v[100:101], v[108:109]
  v_pk_add_f32 v[102:103], v[102:103], v[110:111]
  v_pk_add_f32 v[104:105], v[104:105], v[112:113]
  v_pk_add_f32 v[106:107], v[106:107], v[114:115]
L_ra7:
  s_branch L_rnext
L_rsome:
  s_mov_b32 s74, s71
  s_bitcmp1_b32 s74, 1
  s_cbranch_scc0 L_rb1
  buffer_load_dwordx4 v[20:23], v2, s[28:31], s77 offen sc1
L_rb1:
  s_bitcmp1_b32 s74, 2
  s_cbranch_scc0 L_rb2
  buffer_load_dwordx4 v[24:27], v2, s[28:31], s78 offen sc1
L_rb2:
  s_bitcmp1_b32 s74, 3
  s_cbranch_scc0 L_rb3
  buffer_load_dwordx4 v[28:31], v2, s[28:31], s79 offen sc1
L_rb3:
  s_bitcmp1_b32 s74, 4
  s_cbranch_scc0 L_rb4
  buffer_load_dwordx4 v[32:35], v2, s[28:31], s80 offen sc1
L_rb4:
  s_bitcmp1_b32 s74, 5
  s_cbranch_scc0 L_rb5
  buffer_load_dwordx4 v[36:39], v2, s[28:31], s81 offen sc1
L_rb5:
  s_bitcmp1_b32 s74, 6
  s_cbranch_scc0 L_rb6
  buffer_load_dwordx4 v[40:43], v2, s[28:31], s82 offen sc1
L_rb6:
  s_bitcmp1_b32 s74, 7
  s_cbranch_scc0 L_rb7
  buffer_load_dwordx4 v[44:47], v2, s[28:31], s83 offen sc1
L_rb7:
  s_waitcnt vmcnt(0)
  s_bitcmp1_b32 s74, 1
  s_cbranch_scc0 L_rc1
  v_xor_b32 v5, v20, v52
  v_bitop3_b32 v5, v5, v21, v53 bitop3:0xf6
  v_bitop3_b32 v5, v5, v22, v54 bitop3:0xf6
  v_bitop3_b32 v5, v5, v23, v55 bitop3:0xf6
  v_and_b32 v5, s58, v5
  v_cmp_ne_u32 vcc, 0, v5
  s_cbranch_vccnz L_rc1
  s_bitset0_b32 s71, 1
  v_lshl_or_b32 v108, v20, 16, s47
  v_and_or_b32 v109, v20, v3, s47
  v_lshl_or_b32 v110, v21, 16, s47
  v_and_or_b32 v111, v21, v3, s47
  v_lshl_or_b32 v112, v22, 16, s47
  v_and_or_b32 v113, v22, v3, s47
  v_lshl_or_b32 v114, v23, 16, s47
  v_and_or_b32 v115, v23, v3, s47
  v_pk_add_f32 v[100:101], v[100:101], v[108:109]
  v_pk_add_f32 v[102:103], v[102:103], v[110:111]
  v_pk_add_f32 v[104:105], v[104:105], v[112:113]
  v_pk_add_f32 v[106:107], v[106:107], v[114:115]
L_rc1:
  s_bitcmp1_b32 s74, 2
  s_cbranch_scc0 L_rc2
  v_xor_b32 v5, v24, v52
  v_bitop3_b32 v5, v5, v25, v53 bitop3:0xf6
  v_bitop3_b32 v5, v5, v26, v54 bitop3:0xf6
  v_bitop3_b32 v5, v5, v27, v55 bitop3:0xf6
  v_and_b32 v5, s58, v5
  v_cmp_ne_u32 vcc, 0, v5
  s_cbranch_vccnz L_rc2
  s_bitset0_b32 s71, 2
  v_lshl_or_b32 v108, v24, 16, s47
  v_and_or_b32 v109, v24, v3, s47
  v_lshl_or_b32 v110, v25, 16, s47
  v_and_or_b32 v111, v25, v3, s47
  v_lshl_or_b32 v112, v26, 16, s47
  v_and_or_b32 v113, v26, v3, s47
  v_lshl_or_b32 v114, v27, 16, s47
  v_and_or_b32 v115, v27, v3, s47
  v_pk_add_f32 v[100:101], v[100:101], v[108:109]
  v_pk_add_f32 v[102:103], v[102:103], v[110:111]
  v_pk_add_f32 v[104:105], v[104:105], v[112:113]
  v_pk_add_f32 v[106:107], v[106:107], v[114:115]
L_rc2:
  s_bitcmp1_b32 s74, 3
  s_cbranch_scc0 L_rc3
  v_xor_b32 v5, v28, v52
  v_bitop3_b32 v5, v5, v29, v53 bitop3:0xf6
  v_bitop3_b32 v5, v5, v30, v54 bitop3:0xf6
  v_bitop3_b32 v5, v5, v31, v55 bitop3:0xf6
  v_and_b32 v5, s58, v5
  v_cmp_ne_u32 vcc, 0, v5
  s_cbranch_vccnz L_rc3
  s_bitset0_b32 s71, 3
  v_lshl_or_b32 v108, v28, 16, s47
  v_and_or_b32 v109, v28, v3, s47
  v_lshl_or_b32 v110, v29, 16, s47
  v_and_or_b32 v111, v29, v3, s47
  v_lshl_or_b32 v112, v30, 16, s47
  v_and_or_b32 v113, v30, v3, s47
  v_lshl_or_b32 v114, v31, 16, s47
  v_and_or_b32 v115, v31, v3, s47
  v_pk_add_f32 v[100:101], v[100:101], v[108:109]
  v_pk_add_f32 v[102:103], v[102:103], v[110:111]
  v_pk_add_f32 v[104:105], v[104:105], v[112:113]
  v_pk_add_f32 v[106:107], v[106:107], v[114:115]
L_rc3:
  s_bitcmp1_b32 s74, 4
  s_cbranch_scc0 L_rc4
  v_xor_b32 v5, v32, v52
  v_bitop3_b32 v5, v5, v33, v53 bitop3:0xf6
  v_bitop3_b32 v5, v5, v34, v54 bitop3:0xf6
  v_bitop3_b32 v5, v5, v35, v55 bitop3:0xf6
  v_and_b32 v5, s58, v5
  v_cmp_ne_u32 vcc, 0, v5
  s_cbranch_vccnz L_rc4
  s_bitset0_b32 s71, 4
  v_lshl_or_b32 v108, v32, 16, s47
  v_and_or_b32 v109, v32, v3, s47
  v_lshl_or_b32 v110, v33, 16, s47
  v_and_or_b32 v111, v33, v3, s47
  v_lshl_or_b32 v112, v34, 16, s47
  v_and_or_b32 v113, v34, v3, s47
  v_lshl_or_b32 v114, v35, 16, s47
  v_and_or_b32 v115, v35, v3, s47
  v_pk_add_f32 v[100:101], v[100:101], v[108:109]
  v_pk_add_f32 v[102:103], v[102:103], v[110:111]
  v_pk_add_f32 v[104:105], v[104:105], v[112:113]
  v_pk_add_f32 v[106:107], v[106:107], v[114:115]
L_rc4:
  s_bitcmp1_b32 s74, 5
  s_cbranch_scc0 L_rc5
  v_xor_b32 v5, v36, v52
  v_bitop3_b32 v5, v5, v37, v53 bitop3:0xf6
  v_bitop3_b32 v5, v5, v38, v54 bitop3:0xf6
  v_bitop3_b32 v5, v5, v39, v55 bitop3:0xf6
  v_and_b32 v5, s58, v5
  v_cmp_ne_u32 vcc, 0, v5
  s_cbranch_vccnz L_rc5
  s_bitset0_b32 s71, 5
  v_lshl_or_b32 v108, v36, 16, s47
  v_and_or_b32 v109, v36, v3, s47
  v_lshl_or_b32 v110, v37, 16, s47
  v_and_or_b32 v111, v37, v3, s47
  v_lshl_or_b32 v112, v38, 16, s47
  v_and_or_b32 v113, v38, v3, s47
  v_lshl_or_b32 v114, v39, 16, s47
  v_and_or_b32 v115, v39, v3, s47
  v_pk_add_f32 v[100:101], v[100:101], v[108:109]
  v_pk_add_f32 v[102:103], v[102:103], v[110:111]
  v_pk_add_f32 v[104:105], v[104:105], v[112:113]
  v_pk_add_f32 v[106:107], v[106:107], v[114:115]
L_rc5:
  s_bitcmp1_b32 s74, 6
  s_cbranch_scc0 L_rc6
  v_xor_b32 v5, v40, v52
  v_bitop3_b32 v5, v5, v41, v53 bitop3:0xf6
  v_bitop3_b32 v5, v5, v42, v54 bitop3:0xf6
  v_bitop3_b32 v5, v5, v43, v55 bitop3:0xf6
  v_and_b32 v5, s58, v5
  v_cmp_ne_u32 vcc, 0, v5
  s_cbranch_vccnz L_rc6
  s_bitset0_b32 s71, 6
  v_lshl_or_b32 v108, v40, 16, s47
  v_and_or_b32 v109, v40, v3, s47
  v_lshl_or_b32 v110, v41, 16, s47
  v_and_or_b32 v111, v41, v3, s47
  v_lshl_or_b32 v112, v42, 16, s47
  v_and_or_b32 v113, v42, v3, s47
  v_lshl_or_b32 v114, v43, 16, s47
  v_and_or_b32 v115, v43, v3, s47
  v_pk_add_f32 v[100:101], v[100:101], v[108:109]
  v_pk_add_f32 v[102:103], v[102:103], v[110:111]
  v_pk_add_f32 v[104:105], v[104:105], v[112:113]
  v_pk_add_f32 v[106:107], v[106:107], v[114:115]
L_rc6:
  s_bitcmp1_b32 s74, 7
  s_cbranch_scc0 L_rc7
  v_xor_b32 v5, v44, v52
  v_bitop3_b32 v5, v5, v45, v53 bitop3:0xf6
  v_bitop3_b32 v5, v5, v46, v54 bitop3:0xf6
  v_bitop3_b32 v5, v5, v47, v55 bitop3:0xf6
  v_and_b32 v5, s58, v5
  v_cmp_ne_u32 vcc, 0, v5
  s_cbranch_vccnz L_rc7
  s_bitset0_b32 s71, 7
  v_lshl_or_b32 v108, v44, 16, s47
  v_and_or_b32 v109, v44, v3, s47
  v_lshl_or_b32 v110, v45, 16, s47
  v_and_or_b32 v111, v45, v3, s47
  v_lshl_or_b32 v112, v46, 16, s47
  v_and_or_b32 v113, v46, v3, s47
  v_lshl_or_b32 v114, v47, 16, s47
  v_and_or_b32 v115, v47, v3, s47
  v_pk_add_f32 v[100:101], v[100:101], v[108:109]
  v_pk_add_f32 v[102:103], v[102:103], v[110:111]
  v_pk_add_f32 v[104:105], v[104:105], v[112:113]
  v_pk_add_f32 v[106:107], v[106:107], v[114:115]
L_rc7:
L_rnext:
  s_cmp_lg_u32 s71, 0
  s_cbranch_scc1 L_rpoll
  v_cvt_pk_bf16_f32 v12, v100, v101
  v_cvt_pk_bf16_f32 v14, v104, v105
  v_cvt_pk_bf16_f32 v13, v102, v103
  v_cvt_pk_bf16_f32 v15, v106, v107
  v_permlane16_swap_b32 v12, v14
  s_nop 0
  v_permlane16_swap_b32 v13, v15
  buffer_store_dwordx4 v[12:15], v4, s[24:27], s62 offen sc1
  s_or_b32 s45, s39, s40
  s_or_b32 s45, s45, s60
  s_cmp_lg_u32 s45, 0
  s_cbranch_scc1 L_noep
  s_mov_b64 exec, 1
  v_mov_b32 v9, s32
  buffer_store_dword v9, off, s[28:31], s35 sc1
L_noep:
L_exit:
  s_endpgm
L_compute:
  s_mul_i32 s45, s36, 40
  s_load_dwordx2 s[88:89], s[0:1], 96
  s_load_dwordx2 s[84:85], s[0:1], s45 offset:32
  s_load_dwordx2 s[86:87], s[0:1], 80
  s_lshr_b32 s39, s38, 2
  s_and_b32 s42, s43, 3
  s_mov_b32 s40, s42
  s_lshl2_add_u32 s33, s36, s37
  s_lshl_b32 s35, s33, 8
  s_add_u32 s35, s35, 16777216
  v_and_b32 v144, 15, v0
  v_lshrrev_b32 v145, 4, v0
  v_lshrrev_b32 v146, 1, v144
  s_lshl_b32 s44, s41, 12
  v_lshl_add_u32 v144, v144, 7, s44
  v_xor_b32 v147, v146, v145
  v_lshl_add_u32 v2, v147, 4, v144
  v_add_u32 v2, 82176, v2
  v_xor_b32 v3, 64, v2
  v_lshrrev_b32 v147, 5, v0
  v_xor_b32 v147, v146, v147
  v_lshl_add_u32 v147, v147, 4, v144
  v_and_b32 v145, 1, v145
  v_lshl_add_u32 v147, v145, 3, v147
  v_add_u32 v92, 123264, v147
  v_xor_b32 v93, 32, v92
  v_xor_b32 v94, 64, v92
  v_xor_b32 v95, 96, v92
  v_lshlrev_b32 v1, 4, v0
  s_mov_b32 s53, 41088
  v_bfe_u32 v144, v0, 2, 2
  v_bfe_u32 v145, v0, 4, 1
  v_lshrrev_b32 v146, 5, v0
  v_and_b32 v147, 3, v0
  v_lshlrev_b32 v147, 3, v147
  v_mul_u32_u24 v148, 12352, v145
  v_mul_u32_u24 v149, 3072, v146
  v_add3_u32 v148, v148, v149, v147
  v_lshl_add_u32 v148, v144, 7, v148
  v_lshrrev_b32 v149, 1, v144
  v_lshl_add_u32 v148, v149, 5, v148
  v_add_u32 v4, 98560, v148
  v_xor_b32 v5, 32, v4
  v_mov_b64 v[160:161], 0
  v_mov_b64 v[162:163], 0
  v_mov_b64 v[164:165], 0
  v_mov_b64 v[166:167], 0
  v_mov_b64 v[168:169], 0
  v_mov_b64 v[170:171], 0
  v_mov_b64 v[172:173], 0
  v_mov_b64 v[174:175], 0
  v_mov_b64 v[176:177], 0
  v_mov_b64 v[178:179], 0
  v_mov_b64 v[180:181], 0
  v_mov_b64 v[182:183], 0
  v_mov_b64 v[184:185], 0
  v_mov_b64 v[186:187], 0
  v_mov_b64 v[188:189], 0
  v_mov_b64 v[190:191], 0
  v_mov_b64 v[192:193], 0
  v_mov_b64 v[194:195], 0
  v_mov_b64 v[196:197], 0
  v_mov_b64 v[198:199], 0
  v_mov_b64 v[200:201], 0
  v_mov_b64 v[202:203], 0
  v_mov_b64 v[204:205], 0
  v_mov_b64 v[206:207], 0
  v_mov_b64 v[208:209], 0
  v_mov_b64 v[210:211], 0
  v_mov_b64 v[212:213], 0
  v_mov_b64 v[214:215], 0
  v_mov_b64 v[216:217], 0
  v_mov_b64 v[218:219], 0
  v_mov_b64 v[220:221], 0
  v_mov_b64 v[222:223], 0
  v_mov_b64 v[224:225], 0
  v_mov_b64 v[226:227], 0
  v_mov_b64 v[228:229], 0
  v_mov_b64 v[230:231], 0
  v_mov_b64 v[232:233], 0
  v_mov_b64 v[234:235], 0
  v_mov_b64 v[236:237], 0
  v_mov_b64 v[238:239], 0
  v_mov_b64 v[240:241], 0
  v_mov_b64 v[242:243], 0
  v_mov_b64 v[244:245], 0
  v_mov_b64 v[246:247], 0
  v_mov_b64 v[248:249], 0
  v_mov_b64 v[250:251], 0
  v_mov_b64 v[252:253], 0
  v_mov_b64 v[254:255], 0
  s_waitcnt lgkmcnt(0)
  s_load_dword s32, s[88:89], s35
  s_mov_b32 s28, s88
  s_mov_b32 s29, s89
  s_mov_b32 s30, 268435456
  s_mov_b32 s31, 0x00020000
  s_mov_b32 s48, 82176
  s_mov_b32 s50, 9
  s_mov_b32 s52, 0x3dd53b95
  s_lshl_b32 s44, s33, 2
  s_add_u32 s45, s44, s41
  s_lshl_b32 s45, s45, 3
  s_add_u32 s45, s45, s39
  s_lshl_b32 s51, s45, 13
  s_add_u32 s46, s37, s43
  s_and_b32 s46, s46, 3
  s_and_b32 s47, s38, 4
  s_or_b32 s46, s46, s47
  s_mov_b32 s47, 0xe4
  s_cmp_eq_u32 s46, 1
  s_cselect_b32 s47, 0xb1, s47
  s_cmp_eq_u32 s46, 3
  s_cselect_b32 s47, 0xb1, s47
  s_cmp_eq_u32 s46, 5
  s_cselect_b32 s47, 0xd8, s47
  s_cmp_eq_u32 s46, 7
  s_cselect_b32 s47, 0xd8, s47
  s_bfe_u32 s46, s47, 0x20000
  s_lshl_b32 s46, s46, 11
  s_add_u32 s72, s46, s51
  s_bfe_u32 s46, s47, 0x20002
  s_lshl_b32 s46, s46, 11
  s_add_u32 s73, s46, s51
  s_bfe_u32 s46, s47, 0x20004
  s_lshl_b32 s46, s46, 11
  s_add_u32 s74, s46, s51
  s_bfe_u32 s46, s47, 0x20006
  s_lshl_b32 s46, s46, 11
  s_add_u32 s75, s46, s51
  s_mov_b32 s56, 0x80008000
  s_mov_b32 s57, 0x7fff7fff
  s_mov_b32 s58, 0x10001
  s_mov_b32 s59, 0x07060302
  s_add_u32 s44, s44, s40
  s_mul_i32 s64, s44, 327680
  s_mul_i32 s45, s39, 5120
  s_add_u32 s64, s64, s45
  s_mul_i32 s45, s41, 81920
  s_add_u32 s64, s64, s45
  s_add_u32 s64, s64, 2097152
  s_add_u32 s65, s64, 4096
  s_add_u32 s66, s64, 40960
  s_add_u32 s67, s64, 45056
  s_lshr_b32 s34, s39, 1
  s_lshl_b32 s44, s41, 1
  s_add_u32 s45, s44, 0
  s_cmp_eq_u32 s45, s39
  s_cselect_b32 s45, 0x7ff00000, 0
  v_add_u32 v56, s45, v1
  s_add_u32 s45, s44, 1
  s_cmp_eq_u32 s45, s39
  s_cselect_b32 s45, 0x7ff00000, 0
  v_add_u32 v57, s45, v1
  s_barrier
  ds_read_b128 v[12:15], v2 offset:0
  ds_read_b128 v[16:19], v2 offset:2048
  ds_read_b64_tr_b16 v[28:29], v4 offset:0
  ds_read_b64_tr_b16 v[30:31], v4 offset:512
  ds_read_b64_tr_b16 v[32:33], v5 offset:0
  ds_read_b64_tr_b16 v[34:35], v5 offset:512
  ds_read_b64_tr_b16 v[36:37], v4 offset:64
  ds_read_b64_tr_b16 v[38:39], v4 offset:576
  ds_read_b64_tr_b16 v[40:41], v5 offset:64
  ds_read_b64_tr_b16 v[42:43], v5 offset:576
  ds_read_b64_tr_b16 v[44:45], v4 offset:1024
  ds_read_b64_tr_b16 v[46:47], v4 offset:1536
  ds_read_b64_tr_b16 v[48:49], v5 offset:1024
L_p1:
  s_waitcnt lgkmcnt(9)
  v_mfma_f32_16x16x32_bf16 v[160:163], v[28:31], v[12:15], v[160:163]
  ds_read_b64_tr_b16 v[50:51], v5 offset:1536
  v_mfma_f32_16x16x32_bf16 v[164:167], v[28:31], v[16:19], v[164:167]
  ds_read_b64_tr_b16 v[28:29], v4 offset:1088
  ds_read_b128 v[20:23], v3 offset:0
  s_waitcnt lgkmcnt(10)
  v_mfma_f32_16x16x32_bf16 v[168:171], v[32:35], v[12:15], v[168:171]
  ds_read_b64_tr_b16 v[30:31], v4 offset:1600
  v_mfma_f32_16x16x32_bf16 v[172:175], v[32:35], v[16:19], v[172:175]
  ds_read_b64_tr_b16 v[32:33], v5 offset:1088
  ds_read_b128 v[24:27], v3 offset:2048
  s_waitcnt lgkmcnt(11)
  v_mfma_f32_16x16x32_bf16 v[176:179], v[36:39], v[12:15], v[176:179]
  ds_read_b64_tr_b16 v[34:35], v5 offset:1600
  s_add_u32 s48, s48, 41088
  v_mfma_f32_16x16x32_bf16 v[180:183], v[36:39], v[16:19], v[180:183]
  ds_read_b64_tr_b16 v[36:37], v4 offset:2048
  s_cmp_eq_u32 s48, 123264
  s_waitcnt lgkmcnt(11)
  v_mfma_f32_16x16x32_bf16 v[184:187], v[40:43], v[12:15], v[184:187]
  ds_read_b64_tr_b16 v[38:39], v4 offset:2560
  s_cselect_b32 s48, 0, s48
  v_mfma_f32_16x16x32_bf16 v[188:191], v[40:43], v[16:19], v[188:191]
  ds_read_b64_tr_b16 v[40:41], v5 offset:2048
  s_cselect_b32 s49, -82176, s53
  s_waitcnt lgkmcnt(11)
  v_mfma_f32_16x16x32_bf16 v[192:195], v[44:47], v[12:15], v[192:195]
  ds_read_b64_tr_b16 v[42:43], v5 offset:2560
  v_add_u32 v2, s49, v2
  v_mfma_f32_16x16x32_bf16 v[196:199], v[44:47], v[16:19], v[196:199]
  ds_read_b64_tr_b16 v[44:45], v4 offset:2112
  s_waitcnt lgkmcnt(11)
  v_mfma_f32_16x16x32_bf16 v[200:203], v[48:51], v[12:15], v[200:203]
  ds_read_b64_tr_b16 v[46:47], v4 offset:2624
  v_add_u32 v3, s49, v3
  v_mfma_f32_16x16x32_bf16 v[204:207], v[48:51], v[16:19], v[204:207]
  ds_read_b64_tr_b16 v[48:49], v5 offset:2112
  s_waitcnt lgkmcnt(10)
  v_mfma_f32_16x16x32_bf16 v[208:211], v[28:31], v[12:15], v[208:211]
  ds_read_b64_tr_b16 v[50:51], v5 offset:2624
  s_sub_u32 s50, s50, 1
  v_mfma_f32_16x16x32_bf16 v[212:215], v[28:31], v[16:19], v[212:215]
  ds_read_b64_tr_b16 v[28:29], v4 offset:6144
  s_waitcnt lgkmcnt(9)
  v_mfma_f32_16x16x32_bf16 v[216:219], v[32:35], v[12:15], v[216:219]
  ds_read_b64_tr_b16 v[30:31], v4 offset:6656
  v_mfma_f32_16x16x32_bf16 v[220:223], v[32:35], v[16:19], v[220:223]
  ds_read_b64_tr_b16 v[32:33], v5 offset:6144
  s_waitcnt lgkmcnt(9)
  v_mfma_f32_16x16x32_bf16 v[224:227], v[36:39], v[12:15], v[224:227]
  ds_read_b64_tr_b16 v[34:35], v5 offset:6656
  v_mfma_f32_16x16x32_bf16 v[228:231], v[36:39], v[16:19], v[228:231]
  ds_read_b64_tr_b16 v[36:37], v4 offset:6208
  s_waitcnt lgkmcnt(9)
  v_mfma_f32_16x16x32_bf16 v[232:235], v[40:43], v[12:15], v[232:235]
  ds_read_b64_tr_b16 v[38:39], v4 offset:6720
  v_mfma_f32_16x16x32_bf16 v[236:239], v[40:43], v[16:19], v[236:239]
  ds_read_b64_tr_b16 v[40:41], v5 offset:6208
  s_waitcnt lgkmcnt(9)
  v_mfma_f32_16x16x32_bf16 v[240:243], v[44:47], v[12:15], v[240:243]
  ds_read_b64_tr_b16 v[42:43], v5 offset:6720
  v_mfma_f32_16x16x32_bf16 v[244:247], v[44:47], v[16:19], v[244:247]
  ds_read_b64_tr_b16 v[44:45], v4 offset:7168
  s_waitcnt lgkmcnt(9)
  v_mfma_f32_16x16x32_bf16 v[248:251], v[48:51], v[12:15], v[248:251]
  ds_read_b64_tr_b16 v[46:47], v4 offset:7680
  v_mfma_f32_16x16x32_bf16 v[252:255], v[48:51], v[16:19], v[252:255]
  ds_read_b64_tr_b16 v[48:49], v5 offset:7168
  s_waitcnt lgkmcnt(9)
  v_mfma_f32_16x16x32_bf16 v[160:163], v[28:31], v[20:23], v[160:163]
  ds_read_b64_tr_b16 v[50:51], v5 offset:7680
  v_mfma_f32_16x16x32_bf16 v[164:167], v[28:31], v[24:27], v[164:167]
  ds_read_b64_tr_b16 v[28:29], v4 offset:7232
  s_waitcnt lgkmcnt(9)
  v_mfma_f32_16x16x32_bf16 v[168:171], v[32:35], v[20:23], v[168:171]
  ds_read_b64_tr_b16 v[30:31], v4 offset:7744
  v_mfma_f32_16x16x32_bf16 v[172:175], v[32:35], v[24:27], v[172:175]
  ds_read_b64_tr_b16 v[32:33], v5 offset:7232
  s_waitcnt lgkmcnt(9)
  v_mfma_f32_16x16x32_bf16 v[176:179], v[36:39], v[20:23], v[176:179]
  ds_read_b64_tr_b16 v[34:35], v5 offset:7744
  v_mfma_f32_16x16x32_bf16 v[180:183], v[36:39], v[24:27], v[180:183]
  ds_read_b64_tr_b16 v[36:37], v4 offset:8192
  s_waitcnt lgkmcnt(9)
  v_mfma_f32_16x16x32_bf16 v[184:187], v[40:43], v[20:23], v[184:187]
  ds_read_b64_tr_b16 v[38:39], v4 offset:8704
  v_mfma_f32_16x16x32_bf16 v[188:191], v[40:43], v[24:27], v[188:191]
  ds_read_b64_tr_b16 v[40:41], v5 offset:8192
  s_waitcnt lgkmcnt(9)
  v_mfma_f32_16x16x32_bf16 v[192:195], v[44:47], v[20:23], v[192:195]
  ds_read_b64_tr_b16 v[42:43], v5 offset:8704
  v_mfma_f32_16x16x32_bf16 v[196:199], v[44:47], v[24:27], v[196:199]
  ds_read_b64_tr_b16 v[44:45], v4 offset:8256
  s_waitcnt lgkmcnt(9)
  v_mfma_f32_16x16x32_bf16 v[200:203], v[48:51], v[20:23], v[200:203]
  ds_read_b64_tr_b16 v[46:47], v4 offset:8768
  v_mfma_f32_16x16x32_bf16 v[204:207], v[48:51], v[24:27], v[204:207]
  ds_read_b64_tr_b16 v[48:49], v5 offset:8256
  s_waitcnt lgkmcnt(9)
  v_mfma_f32_16x16x32_bf16 v[208:211], v[28:31], v[20:23], v[208:211]
  ds_read_b64_tr_b16 v[50:51], v5 offset:8768
  v_mfma_f32_16x16x32_bf16 v[212:215], v[28:31], v[24:27], v[212:215]
  v_add_u32 v4, s49, v4
  v_add_u32 v5, s49, v5
  s_waitcnt lgkmcnt(8)
  v_mfma_f32_16x16x32_bf16 v[216:219], v[32:35], v[20:23], v[216:219]
  v_mfma_f32_16x16x32_bf16 v[220:223], v[32:35], v[24:27], v[220:223]
  s_bitcmp1_b32 48, s50
  s_cbranch_scc1 L_p1_k
L_p1_nk:
  s_waitcnt lgkmcnt(0)
  s_barrier
  ds_read_b128 v[12:15], v2 offset:0
  ds_read_b128 v[16:19], v2 offset:2048
  ds_read_b64_tr_b16 v[28:29], v4 offset:0
  ds_read_b64_tr_b16 v[30:31], v4 offset:512
  v_mfma_f32_16x16x32_bf16 v[224:227], v[36:39], v[20:23], v[224:227]
  ds_read_b64_tr_b16 v[32:33], v5 offset:0
  ds_read_b64_tr_b16 v[34:35], v5 offset:512
  v_mfma_f32_16x16x32_bf16 v[228:231], v[36:39], v[24:27], v[228:231]
  ds_read_b64_tr_b16 v[36:37], v4 offset:64
  v_mfma_f32_16x16x32_bf16 v[232:235], v[40:43], v[20:23], v[232:235]
  ds_read_b64_tr_b16 v[38:39], v4 offset:576
  v_mfma_f32_16x16x32_bf16 v[236:239], v[40:43], v[24:27], v[236:239]
  ds_read_b64_tr_b16 v[40:41], v5 offset:64
  v_mfma_f32_16x16x32_bf16 v[240:243], v[44:47], v[20:23], v[240:243]
  ds_read_b64_tr_b16 v[42:43], v5 offset:576
  v_mfma_f32_16x16x32_bf16 v[244:247], v[44:47], v[24:27], v[244:247]
  ds_read_b64_tr_b16 v[44:45], v4 offset:1024
  v_mfma_f32_16x16x32_bf16 v[248:251], v[48:51], v[20:23], v[248:251]
  ds_read_b64_tr_b16 v[46:47], v4 offset:1536
  s_cmp_lg_u32 s50, 0
  v_mfma_f32_16x16x32_bf16 v[252:255], v[48:51], v[24:27], v[252:255]
  ds_read_b64_tr_b16 v[48:49], v5 offset:1024
  s_cbranch_scc1 L_p1
  s_waitcnt lgkmcnt(9)
  v_mfma_f32_16x16x32_bf16 v[160:163], v[28:31], v[12:15], v[160:163]
  ds_read_b64_tr_b16 v[50:51], v5 offset:1536
  v_mfma_f32_16x16x32_bf16 v[164:167], v[28:31], v[16:19], v[164:167]
  ds_read_b64_tr_b16 v[28:29], v4 offset:1088
  ds_read_b128 v[20:23], v3 offset:0
  s_waitcnt lgkmcnt(10)
  v_mfma_f32_16x16x32_bf16 v[168:171], v[32:35], v[12:15], v[168:171]
  ds_read_b64_tr_b16 v[30:31], v4 offset:1600
  v_mfma_f32_16x16x32_bf16 v[172:175], v[32:35], v[16:19], v[172:175]
  ds_read_b64_tr_b16 v[32:33], v5 offset:1088
  ds_read_b128 v[24:27], v3 offset:2048
  s_waitcnt lgkmcnt(11)
  v_mfma_f32_16x16x32_bf16 v[176:179], v[36:39], v[12:15], v[176:179]
  ds_read_b64_tr_b16 v[34:35], v5 offset:1600
  s_add_u32 s48, s48, 41088
  v_mfma_f32_16x16x32_bf16 v[180:183], v[36:39], v[16:19], v[180:183]
  ds_read_b64_tr_b16 v[36:37], v4 offset:2048
  s_cmp_eq_u32 s48, 123264
  s_waitcnt lgkmcnt(11)
  v_mfma_f32_16x16x32_bf16 v[184:187], v[40:43], v[12:15], v[184:187]
  ds_read_b64_tr_b16 v[38:39], v4 offset:2560
  s_cselect_b32 s48, 0, s48
  v_mfma_f32_16x16x32_bf16 v[188:191], v[40:43], v[16:19], v[188:191]
  ds_read_b64_tr_b16 v[40:41], v5 offset:2048
  s_cselect_b32 s49, -82176, s53
  s_waitcnt lgkmcnt(11)
  v_mfma_f32_16x16x32_bf16 v[192:195], v[44:47], v[12:15], v[192:195]
  ds_read_b64_tr_b16 v[42:43], v5 offset:2560
  v_add_u32 v2, s49, v2
  v_mfma_f32_16x16x32_bf16 v[196:199], v[44:47], v[16:19], v[196:199]
  ds_read_b64_tr_b16 v[44:45], v4 offset:2112
  s_waitcnt lgkmcnt(11)
  v_mfma_f32_16x16x32_bf16 v[200:203], v[48:51], v[12:15], v[200:203]
  ds_read_b64_tr_b16 v[46:47], v4 offset:2624
  v_add_u32 v3, s49, v3
  v_mfma_f32_16x16x32_bf16 v[204:207], v[48:51], v[16:19], v[204:207]
  ds_read_b64_tr_b16 v[48:49], v5 offset:2112
  s_waitcnt lgkmcnt(10)
  v_mfma_f32_16x16x32_bf16 v[208:211], v[28:31], v[12:15], v[208:211]
  ds_read_b64_tr_b16 v[50:51], v5 offset:2624
  v_mfma_f32_16x16x32_bf16 v[212:215], v[28:31], v[16:19], v[212:215]
  ds_read_b64_tr_b16 v[28:29], v4 offset:6144
  s_waitcnt lgkmcnt(9)
  v_mfma_f32_16x16x32_bf16 v[216:219], v[32:35], v[12:15], v[216:219]
  ds_read_b64_tr_b16 v[30:31], v4 offset:6656
  v_mfma_f32_16x16x32_bf16 v[220:223], v[32:35], v[16:19], v[220:223]
  ds_read_b64_tr_b16 v[32:33], v5 offset:6144
  s_waitcnt lgkmcnt(9)
  v_mfma_f32_16x16x32_bf16 v[224:227], v[36:39], v[12:15], v[224:227]
  ds_read_b64_tr_b16 v[34:35], v5 offset:6656
  v_mfma_f32_16x16x32_bf16 v[228:231], v[36:39], v[16:19], v[228:231]
  ds_read_b64_tr_b16 v[36:37], v4 offset:6208
  s_waitcnt lgkmcnt(9)
  v_mfma_f32_16x16x32_bf16 v[232:235], v[40:43], v[12:15], v[232:235]
  ds_read_b64_tr_b16 v[38:39], v4 offset:6720
  v_mfma_f32_16x16x32_bf16 v[236:239], v[40:43], v[16:19], v[236:239]
  ds_read_b64_tr_b16 v[40:41], v5 offset:6208
  s_waitcnt lgkmcnt(9)
  v_mfma_f32_16x16x32_bf16 v[240:243], v[44:47], v[12:15], v[240:243]
  ds_read_b64_tr_b16 v[42:43], v5 offset:6720
  v_mfma_f32_16x16x32_bf16 v[244:247], v[44:47], v[16:19], v[244:247]
  ds_read_b64_tr_b16 v[44:45], v4 offset:7168
  s_waitcnt lgkmcnt(9)
  v_mfma_f32_16x16x32_bf16 v[248:251], v[48:51], v[12:15], v[248:251]
  ds_read_b64_tr_b16 v[46:47], v4 offset:7680
  v_mfma_f32_16x16x32_bf16 v[252:255], v[48:51], v[16:19], v[252:255]
  ds_read_b64_tr_b16 v[48:49], v5 offset:7168
  s_waitcnt lgkmcnt(9)
  v_mfma_f32_16x16x32_bf16 v[160:163], v[28:31], v[20:23], v[160:163]
  ds_read_b64_tr_b16 v[50:51], v5 offset:7680
  v_mfma_f32_16x16x32_bf16 v[164:167], v[28:31], v[24:27], v[164:167]
  ds_read_b64_tr_b16 v[28:29], v4 offset:7232
  s_waitcnt lgkmcnt(9)
  v_mfma_f32_16x16x32_bf16 v[168:171], v[32:35], v[20:23], v[168:171]
  ds_read_b64_tr_b16 v[30:31], v4 offset:7744
  v_mfma_f32_16x16x32_bf16 v[172:175], v[32:35], v[24:27], v[172:175]
  ds_read_b64_tr_b16 v[32:33], v5 offset:7232
  s_waitcnt lgkmcnt(9)
  v_mfma_f32_16x16x32_bf16 v[176:179], v[36:39], v[20:23], v[176:179]
  ds_read_b64_tr_b16 v[34:35], v5 offset:7744
  v_mfma_f32_16x16x32_bf16 v[180:183], v[36:39], v[24:27], v[180:183]
  ds_read_b64_tr_b16 v[36:37], v4 offset:8192
  s_waitcnt lgkmcnt(9)
  v_mfma_f32_16x16x32_bf16 v[184:187], v[40:43], v[20:23], v[184:187]
  ds_read_b64_tr_b16 v[38:39], v4 offset:8704
  v_mfma_f32_16x16x32_bf16 v[188:191], v[40:43], v[24:27], v[188:191]
  ds_read_b64_tr_b16 v[40:41], v5 offset:8192
  s_waitcnt lgkmcnt(9)
  v_mfma_f32_16x16x32_bf16 v[192:195], v[44:47], v[20:23], v[192:195]
  ds_read_b64_tr_b16 v[42:43], v5 offset:8704
  v_cvt_pk_bf16_f32 v160, v160, v161
  v_mfma_f32_16x16x32_bf16 v[196:199], v[44:47], v[24:27], v[196:199]
  ds_read_b64_tr_b16 v[44:45], v4 offset:8256
  s_waitcnt lgkmcnt(9)
  v_mfma_f32_16x16x32_bf16 v[200:203], v[48:51], v[20:23], v[200:203]
  ds_read_b64_tr_b16 v[46:47], v4 offset:8768
  v_cvt_pk_bf16_f32 v161, v162, v163
  v_mfma_f32_16x16x32_bf16 v[204:207], v[48:51], v[24:27], v[204:207]
  ds_read_b64_tr_b16 v[48:49], v5 offset:8256
  s_waitcnt lgkmcnt(9)
  v_mfma_f32_16x16x32_bf16 v[208:211], v[28:31], v[20:23], v[208:211]
  ds_read_b64_tr_b16 v[50:51], v5 offset:8768
  v_cvt_pk_bf16_f32 v162, v168, v169
  v_mfma_f32_16x16x32_bf16 v[212:215], v[28:31], v[24:27], v[212:215]
  v_add_u32 v4, s49, v4
  v_add_u32 v5, s49, v5
  s_waitcnt lgkmcnt(8)
  v_mfma_f32_16x16x32_bf16 v[216:219], v[32:35], v[20:23], v[216:219]
  v_cvt_pk_bf16_f32 v163, v170, v171
  v_mfma_f32_16x16x32_bf16 v[220:223], v[32:35], v[24:27], v[220:223]
  s_waitcnt lgkmcnt(0)
  s_barrier
  ds_read_b64 v[128:129], v92 offset:0
  ds_read_b64 v[130:131], v93 offset:0
  ds_read_b64 v[132:133], v92 offset:2048
  ds_read_b64 v[134:135], v93 offset:2048
  ds_read_b64 v[136:137], v94 offset:0
  ds_read_b64 v[138:139], v95 offset:0
  ds_read_b64 v[140:141], v94 offset:2048
  ds_read_b64 v[142:143], v95 offset:2048
  v_mfma_f32_16x16x32_bf16 v[224:227], v[36:39], v[20:23], v[224:227]
  v_cvt_pk_bf16_f32 v164, v164, v165
  v_mfma_f32_16x16x32_bf16 v[228:231], v[36:39], v[24:27], v[228:231]
  v_mfma_f32_16x16x32_bf16 v[232:235], v[40:43], v[20:23], v[232:235]
  v_cvt_pk_bf16_f32 v165, v166, v167
  v_mfma_f32_16x16x32_bf16 v[236:239], v[40:43], v[24:27], v[236:239]
  v_mfma_f32_16x16x32_bf16 v[240:243], v[44:47], v[20:23], v[240:243]
  v_cvt_pk_bf16_f32 v166, v172, v173
  v_mfma_f32_16x16x32_bf16 v[244:247], v[44:47], v[24:27], v[244:247]
  v_mfma_f32_16x16x32_bf16 v[248:251], v[48:51], v[20:23], v[248:251]
  v_cvt_pk_bf16_f32 v167, v174, v175
  v_mfma_f32_16x16x32_bf16 v[252:255], v[48:51], v[24:27], v[252:255]
  v_mfma_f32_16x16x32_bf16 v[76:79], v[96:99], v[160:163], 0
  v_cvt_pk_bf16_f32 v176, v176, v177
  v_cvt_pk_bf16_f32 v177, v178, v179
  v_bfe_u32 v144, v0, 2, 2
  v_mfma_f32_16x16x32_bf16 v[80:83], v[100:103], v[160:163], 0
  v_cvt_pk_bf16_f32 v178, v184, v185
  v_cvt_pk_bf16_f32 v179, v186, v187
  v_bfe_u32 v145, v0, 4, 1
  v_mfma_f32_16x16x32_bf16 v[84:87], v[96:99], v[164:167], 0
  v_cvt_pk_bf16_f32 v180, v180, v181
  v_cvt_pk_bf16_f32 v181, v182, v183
  v_lshrrev_b32 v146, 5, v0
  v_mfma_f32_16x16x32_bf16 v[88:91], v[100:103], v[164:167], 0
  v_cvt_pk_bf16_f32 v182, v188, v189
  v_cvt_pk_bf16_f32 v183, v190, v191
  v_and_b32 v147, 3, v0
  v_mfma_f32_16x16x32_bf16 v[76:79], v[104:107], v[176:179], v[76:79]
  v_cvt_pk_bf16_f32 v192, v192, v193
  v_cvt_pk_bf16_f32 v193, v194, v195
  v_lshlrev_b32 v147, 3, v147
  v_mfma_f32_16x16x32_bf16 v[80:83], v[108:111], v[176:179], v[80:83]
  v_cvt_pk_bf16_f32 v194, v200, v201
  v_cvt_pk_bf16_f32 v195, v202, v203
  v_mul_u32_u24 v148, 8256, v145
  v_mfma_f32_16x16x32_bf16 v[84:87], v[104:107], v[180:183], v[84:87]
  v_cvt_pk_bf16_f32 v196, v196, v197
  v_cvt_pk_bf16_f32 v197, v198, v199
  v_mul_u32_u24 v149, 2048, v146
  v_mfma_f32_16x16x32_bf16 v[88:91], v[108:111], v[180:183], v[88:91]
  v_cvt_pk_bf16_f32 v198, v204, v205
  v_cvt_pk_bf16_f32 v199, v206, v207
  v_add3_u32 v148, v148, v149, v147
  v_mfma_f32_16x16x32_bf16 v[76:79], v[112:115], v[192:195], v[76:79]
  v_cvt_pk_bf16_f32 v208, v208, v209
  v_cvt_pk_bf16_f32 v209, v210, v211
  v_lshl_add_u32 v148, v144, 7, v148
  v_mfma_f32_16x16x32_bf16 v[80:83], v[116:119], v[192:195], v[80:83]
  v_cvt_pk_bf16_f32 v210, v216, v217
  v_cvt_pk_bf16_f32 v211, v218, v219
  v_lshrrev_b32 v149, 1, v144
  v_mfma_f32_16x16x32_bf16 v[84:87], v[112:115], v[196:199], v[84:87]
  v_cvt_pk_bf16_f32 v212, v212, v213
  v_cvt_pk_bf16_f32 v213, v214, v215
  v_lshl_add_u32 v148, v149, 5, v148
  v_mfma_f32_16x16x32_bf16 v[88:91], v[116:119], v[196:199], v[88:91]
  v_cvt_pk_bf16_f32 v214, v220, v221
  v_cvt_pk_bf16_f32 v215, v222, v223
  v_add_u32 v4, 16384, v148
  v_mfma_f32_16x16x32_bf16 v[76:79], v[120:123], v[208:211], v[76:79]
  v_cvt_pk_bf16_f32 v224, v224, v225
  v_cvt_pk_bf16_f32 v225, v226, v227
  v_xor_b32 v5, 32, v4
  v_mfma_f32_16x16x32_bf16 v[80:83], v[124:127], v[208:211], v[80:83]
  v_cvt_pk_bf16_f32 v226, v232, v233
  v_cvt_pk_bf16_f32 v227, v234, v235
  v_mul_u32_u24 v148, 544, v145
  v_mfma_f32_16x16x32_bf16 v[84:87], v[120:123], v[212:215], v[84:87]
  v_cvt_pk_bf16_f32 v228, v228, v229
  v_cvt_pk_bf16_f32 v229, v230, v231
  v_lshl_add_u32 v148, v146, 10, v148
  v_mfma_f32_16x16x32_bf16 v[88:91], v[124:127], v[212:215], v[88:91]
  v_cvt_pk_bf16_f32 v230, v236, v237
  v_cvt_pk_bf16_f32 v231, v238, v239
  v_lshl_add_u32 v148, v144, 6, v148
  s_waitcnt lgkmcnt(0)
  v_mfma_f32_16x16x32_bf16 v[76:79], v[128:131], v[224:227], v[76:79]
  v_cvt_pk_bf16_f32 v240, v240, v241
  v_cvt_pk_bf16_f32 v241, v242, v243
  v_add_u32 v148, v148, v147
  v_mfma_f32_16x16x32_bf16 v[80:83], v[132:135], v[224:227], v[80:83]
  v_cvt_pk_bf16_f32 v242, v248, v249
  v_cvt_pk_bf16_f32 v243, v250, v251
  v_add_u32 v6, 33024, v148
  v_mfma_f32_16x16x32_bf16 v[84:87], v[128:131], v[228:231], v[84:87]
  v_cvt_pk_bf16_f32 v244, v244, v245
  v_cvt_pk_bf16_f32 v245, v246, v247
  v_xor_b32 v7, 32, v6
  v_mfma_f32_16x16x32_bf16 v[88:91], v[132:135], v[228:231], v[88:91]
  v_cvt_pk_bf16_f32 v246, v252, v253
  v_cvt_pk_bf16_f32 v247, v254, v255
  v_mfma_f32_16x16x32_bf16 v[76:79], v[136:139], v[240:243], v[76:79]
  v_mfma_f32_16x16x32_bf16 v[80:83], v[140:143], v[240:243], v[80:83]
  v_mfma_f32_16x16x32_bf16 v[84:87], v[136:139], v[244:247], v[84:87]
  v_mfma_f32_16x16x32_bf16 v[88:91], v[140:143], v[244:247], v[88:91]
  s_nop 4
  v_max3_f32 v8, v76, v77, v78
  s_nop 0
  v_max3_f32 v9, v84, v85, v86
  v_max3_f32 v8, v8, v79, v80
  v_max3_f32 v9, v9, v87, v88
  v_max3_f32 v8, v8, v81, v82
  v_max3_f32 v9, v9, v89, v90
  v_max_f32 v8, v8, v83
  v_max_f32 v9, v9, v91
  s_nop 1
  v_permlane32_swap_b32 v8, v9
  v_max_f32 v8, v8, v9
  v_mov_b32 v9, v8
  s_nop 1
  v_permlane16_swap_b32 v8, v9
  v_max_f32 v8, v8, v9
  v_mul_f32 v8, s52, v8
  v_mov_b32 v9, v8
  s_nop 1
  v_permlane32_swap_b32 v8, v9
  s_mov_b32 s50, 0
  s_barrier
  ds_read_b128 v[12:15], v2 offset:0
  ds_read_b128 v[16:19], v2 offset:2048
  ds_read_b64_tr_b16 v[28:29], v4 offset:0
  ds_read_b64_tr_b16 v[30:31], v4 offset:512
  ds_read_b64_tr_b16 v[32:33], v5 offset:0
  ds_read_b64_tr_b16 v[34:35], v5 offset:512
  ds_read_b64_tr_b16 v[36:37], v4 offset:64
  ds_read_b64_tr_b16 v[38:39], v4 offset:576
  ds_read_b64_tr_b16 v[40:41], v5 offset:64
  ds_read_b64_tr_b16 v[42:43], v5 offset:576
  ds_read_b64_tr_b16 v[44:45], v4 offset:1024
  s_waitcnt lgkmcnt(7)
  v_mfma_f32_16x16x32_bf16 v[96:99], v[12:15], v[28:31], 0
  ds_read_b64_tr_b16 v[46:47], v4 offset:1536
  v_fma_f32 v76, v76, s52, -v8
  v_fma_f32 v77, v77, s52, -v8
  v_fma_f32 v78, v78, s52, -v8
  v_mfma_f32_16x16x32_bf16 v[100:103], v[16:19], v[28:31], 0
  ds_read_b64_tr_b16 v[28:29], v5 offset:1024
  ds_read_b128 v[20:23], v3 offset:0
  v_exp_f32 v76, v76
  v_fma_f32 v79, v79, s52, -v8
  v_exp_f32 v77, v77
  s_waitcnt lgkmcnt(8)
  v_mfma_f32_16x16x32_bf16 v[104:107], v[12:15], v[32:35], 0
  ds_read_b64_tr_b16 v[30:31], v5 offset:1536
  v_fma_f32 v80, v80, s52, -v8
  v_exp_f32 v78, v78
  v_fma_f32 v81, v81, s52, -v8
  v_mfma_f32_16x16x32_bf16 v[108:111], v[16:19], v[32:35], 0
  ds_read_b64_tr_b16 v[32:33], v4 offset:1088
  ds_read_b128 v[24:27], v3 offset:2048
  v_exp_f32 v79, v79
  v_fma_f32 v82, v82, s52, -v8
  v_exp_f32 v80, v80
  s_waitcnt lgkmcnt(9)
  v_mfma_f32_16x16x32_bf16 v[112:115], v[12:15], v[36:39], 0
  ds_read_b64_tr_b16 v[34:35], v4 offset:1600
  s_add_u32 s48, s48, 41088
  v_fma_f32 v83, v83, s52, -v8
  v_exp_f32 v81, v81
  v_fma_f32 v84, v84, s52, -v9
  v_mfma_f32_16x16x32_bf16 v[116:119], v[16:19], v[36:39], 0
  ds_read_b64_tr_b16 v[36:37], v5 offset:1088
  s_cmp_eq_u32 s48, 164352
  v_exp_f32 v82, v82
  v_fma_f32 v85, v85, s52, -v9
  v_exp_f32 v83, v83
  s_waitcnt lgkmcnt(9)
  v_mfma_f32_16x16x32_bf16 v[120:123], v[12:15], v[40:43], 0
  ds_read_b64_tr_b16 v[38:39], v5 offset:1600
  s_cselect_b32 s48, 0, s48
  v_fma_f32 v86, v86, s52, -v9
  v_exp_f32 v84, v84
  v_fma_f32 v87, v87, s52, -v9
  v_mfma_f32_16x16x32_bf16 v[124:127], v[16:19], v[40:43], 0
  ds_read_b64_tr_b16 v[40:41], v6 offset:0
  s_cselect_b32 s49, -123264, s53
  v_exp_f32 v85, v85
  v_fma_f32 v88, v88, s52, -v9
  v_exp_f32 v86, v86
  s_waitcnt lgkmcnt(9)
  v_mfma_f32_16x16x32_bf16 v[128:131], v[12:15], v[44:47], 0
  ds_read_b64_tr_b16 v[42:43], v6 offset:256
  v_add_u32 v2, s49, v2
  v_fma_f32 v89, v89, s52, -v9
  v_exp_f32 v87, v87
  v_fma_f32 v90, v90, s52, -v9
  v_mfma_f32_16x16x32_bf16 v[132:135], v[16:19], v[44:47], 0
  ds_read_b64_tr_b16 v[44:45], v7 offset:0
  v_exp_f32 v88, v88
  v_fma_f32 v91, v91, s52, -v9
  v_exp_f32 v89, v89
  s_waitcnt lgkmcnt(8)
  v_mfma_f32_16x16x32_bf16 v[136:139], v[12:15], v[28:31], 0
  ds_read_b64_tr_b16 v[46:47], v7 offset:256
  v_add_u32 v3, s49, v3
  v_exp_f32 v90, v90
  v_exp_f32 v91, v91
  v_add_f32 v8, v76, v77
  v_mfma_f32_16x16x32_bf16 v[140:143], v[16:19], v[28:31], 0
  ds_read_b64_tr_b16 v[28:29], v4 offset:4096
  v_add_f32 v9, v84, v85
  v_add_f32 v8, v8, v78
  v_add_f32 v9, v9, v86
  s_waitcnt lgkmcnt(7)
  v_mfma_f32_16x16x32_bf16 v[144:147], v[12:15], v[32:35], 0
  ds_read_b64_tr_b16 v[30:31], v4 offset:4608
  v_add_f32 v8, v8, v79
  v_add_f32 v9, v9, v87
  v_add_f32 v8, v8, v80
  v_mfma_f32_16x16x32_bf16 v[148:151], v[16:19], v[32:35], 0
  ds_read_b64_tr_b16 v[32:33], v5 offset:4096
  v_add_f32 v9, v9, v88
  v_add_f32 v8, v8, v81
  v_add_f32 v9, v9, v89
  s_waitcnt lgkmcnt(7)
  v_mfma_f32_16x16x32_bf16 v[152:155], v[12:15], v[36:39], 0
  ds_read_b64_tr_b16 v[34:35], v5 offset:4608
  v_add_f32 v8, v8, v82
  v_add_f32 v9, v9, v90
  v_add_f32 v8, v8, v83
  v_mfma_f32_16x16x32_bf16 v[156:159], v[16:19], v[36:39], 0
  ds_read_b64_tr_b16 v[36:37], v4 offset:4160
  v_add_f32 v9, v9, v91
  s_waitcnt lgkmcnt(7)
  v_mfma_f32_16x16x32_bf16 v[160:163], v[12:15], v[40:43], 0
  ds_read_b64_tr_b16 v[38:39], v4 offset:4672
  v_permlane32_swap_b32 v8, v9
  v_add_f32 v8, v8, v9
  v_mov_b32 v9, v8
  v_mfma_f32_16x16x32_bf16 v[164:167], v[16:19], v[40:43], 0
  ds_read_b64_tr_b16 v[40:41], v5 offset:4160
  v_permlane16_swap_b32 v8, v9
  v_add_f32 v8, v8, v9
  v_rcp_f32 v8, v8
  s_waitcnt lgkmcnt(7)
  v_mfma_f32_16x16x32_bf16 v[168:171], v[12:15], v[44:47], 0
  ds_read_b64_tr_b16 v[42:43], v5 offset:4672
  v_mov_b32 v9, v8
  v_mfma_f32_16x16x32_bf16 v[172:175], v[16:19], v[44:47], 0
  ds_read_b64_tr_b16 v[44:45], v4 offset:5120
  v_permlane32_swap_b32 v8, v9
  v_mul_f32 v76, v76, v8
  v_mul_f32 v77, v77, v8
  s_waitcnt lgkmcnt(7)
  v_mfma_f32_16x16x32_bf16 v[96:99], v[20:23], v[28:31], v[96:99]
  ds_read_b64_tr_b16 v[46:47], v4 offset:5632
  v_mul_f32 v78, v78, v8
  v_mul_f32 v79, v79, v8
  v_mul_f32 v80, v80, v8
  v_mfma_f32_16x16x32_bf16 v[100:103], v[24:27], v[28:31], v[100:103]
  ds_read_b64_tr_b16 v[28:29], v5 offset:5120
  v_mul_f32 v81, v81, v8
  v_mul_f32 v82, v82, v8
  v_mul_f32 v83, v83, v8
  s_waitcnt lgkmcnt(7)
  v_mfma_f32_16x16x32_bf16 v[104:107], v[20:23], v[32:35], v[104:107]
  ds_read_b64_tr_b16 v[30:31], v5 offset:5632
  v_mul_f32 v84, v84, v9
  v_mul_f32 v85, v85, v9
  v_mfma_f32_16x16x32_bf16 v[108:111], v[24:27], v[32:35], v[108:111]
  ds_read_b64_tr_b16 v[32:33], v4 offset:5184
  v_mul_f32 v86, v86, v9
  v_mul_f32 v87, v87, v9
  s_waitcnt lgkmcnt(7)
  v_mfma_f32_16x16x32_bf16 v[112:115], v[20:23], v[36:39], v[112:115]
  ds_read_b64_tr_b16 v[34:35], v4 offset:5696
  v_mul_f32 v88, v88, v9
  v_mul_f32 v89, v89, v9
  v_mfma_f32_16x16x32_bf16 v[116:119], v[24:27], v[36:39], v[116:119]
  ds_read_b64_tr_b16 v[36:37], v5 offset:5184
  v_mul_f32 v90, v90, v9
  v_mul_f32 v91, v91, v9
  s_waitcnt lgkmcnt(7)
  v_mfma_f32_16x16x32_bf16 v[120:123], v[20:23], v[40:43], v[120:123]
  ds_read_b64_tr_b16 v[38:39], v5 offset:5696
  v_cvt_pk_bf16_f32 v68, v76, v77
  v_cvt_pk_bf16_f32 v69, v78, v79
  v_mfma_f32_16x16x32_bf16 v[124:127], v[24:27], v[40:43], v[124:127]
  ds_read_b64_tr_b16 v[40:41], v6 offset:2048
  v_cvt_pk_bf16_f32 v70, v80, v81
  v_cvt_pk_bf16_f32 v71, v82, v83
  s_waitcnt lgkmcnt(7)
  v_mfma_f32_16x16x32_bf16 v[128:131], v[20:23], v[44:47], v[128:131]
  ds_read_b64_tr_b16 v[42:43], v6 offset:2304
  v_cvt_pk_bf16_f32 v72, v84, v85
  v_cvt_pk_bf16_f32 v73, v86, v87
  v_mfma_f32_16x16x32_bf16 v[132:135], v[24:27], v[44:47], v[132:135]
  ds_read_b64_tr_b16 v[44:45], v7 offset:2048
  v_cvt_pk_bf16_f32 v74, v88, v89
  v_cvt_pk_bf16_f32 v75, v90, v91
  s_waitcnt lgkmcnt(7)
  v_mfma_f32_16x16x32_bf16 v[136:139], v[20:23], v[28:31], v[136:139]
  ds_read_b64_tr_b16 v[46:47], v7 offset:2304
  v_bfi_b32 v68, s56, v52, v68
  v_bfi_b32 v69, s56, v53, v69
  v_mfma_f32_16x16x32_bf16 v[140:143], v[24:27], v[28:31], v[140:143]
  v_add_u32 v4, s49, v4
  v_add_u32 v5, s49, v5
  v_bfi_b32 v70, s56, v54, v70
  v_bfi_b32 v71, s56, v55, v71
  s_waitcnt lgkmcnt(6)
  v_mfma_f32_16x16x32_bf16 v[144:147], v[20:23], v[32:35], v[144:147]
  v_add_u32 v6, s49, v6
  v_add_u32 v7, s49, v7
  v_bfi_b32 v72, s56, v52, v72
  v_bfi_b32 v73, s56, v53, v73
  v_mfma_f32_16x16x32_bf16 v[148:151], v[24:27], v[32:35], v[148:151]
  v_bfi_b32 v74, s56, v54, v74
  v_bfi_b32 v75, s56, v55, v75
  s_lshl_b32 s44, s42, 11
  s_add_u32 s44, s44, s51
  buffer_store_dwordx4 v[68:71], v1, s[28:31], s44 offen sc1
  buffer_store_dwordx4 v[72:75], v1, s[28:31], s44 offen offset:1024 sc1
  s_waitcnt lgkmcnt(0)
  s_barrier
  ds_read_b128 v[12:15], v2 offset:0
  ds_read_b128 v[16:19], v2 offset:2048
  ds_read_b64_tr_b16 v[28:29], v4 offset:0
  ds_read_b64_tr_b16 v[30:31], v4 offset:512
  v_mfma_f32_16x16x32_bf16 v[152:155], v[20:23], v[36:39], v[152:155]
  ds_read_b64_tr_b16 v[32:33], v5 offset:0
  ds_read_b64_tr_b16 v[34:35], v5 offset:512
  v_mfma_f32_16x16x32_bf16 v[156:159], v[24:27], v[36:39], v[156:159]
  ds_read_b64_tr_b16 v[36:37], v4 offset:64
  v_mfma_f32_16x16x32_bf16 v[160:163], v[20:23], v[40:43], v[160:163]
  ds_read_b64_tr_b16 v[38:39], v4 offset:576
  v_mfma_f32_16x16x32_bf16 v[164:167], v[24:27], v[40:43], v[164:167]
  ds_read_b64_tr_b16 v[40:41], v5 offset:64
  v_mfma_f32_16x16x32_bf16 v[168:171], v[20:23], v[44:47], v[168:171]
  ds_read_b64_tr_b16 v[42:43], v5 offset:576
  v_mfma_f32_16x16x32_bf16 v[172:175], v[24:27], v[44:47], v[172:175]
  ds_read_b64_tr_b16 v[44:45], v4 offset:1024
L_p2_b:
  s_waitcnt lgkmcnt(7)
  v_mfma_f32_16x16x32_bf16 v[96:99], v[12:15], v[28:31], v[96:99]
  ds_read_b64_tr_b16 v[46:47], v4 offset:1536
  v_mfma_f32_16x16x32_bf16 v[100:103], v[16:19], v[28:31], v[100:103]
  ds_read_b64_tr_b16 v[28:29], v5 offset:1024
  ds_read_b128 v[20:23], v3 offset:0
  s_waitcnt lgkmcnt(8)
  v_mfma_f32_16x16x32_bf16 v[104:107], v[12:15], v[32:35], v[104:107]
  ds_read_b64_tr_b16 v[30:31], v5 offset:1536
  v_mfma_f32_16x16x32_bf16 v[108:111], v[16:19], v[32:35], v[108:111]
  ds_read_b64_tr_b16 v[32:33], v4 offset:1088
  ds_read_b128 v[24:27], v3 offset:2048
  s_waitcnt lgkmcnt(9)
  v_mfma_f32_16x16x32_bf16 v[112:115], v[12:15], v[36:39], v[112:115]
  ds_read_b64_tr_b16 v[34:35], v4 offset:1600
  s_add_u32 s48, s48, 41088
  v_mfma_f32_16x16x32_bf16 v[116:119], v[16:19], v[36:39], v[116:119]
  ds_read_b64_tr_b16 v[36:37], v5 offset:1088
  s_cmp_eq_u32 s48, 164352
  s_waitcnt lgkmcnt(9)
  v_mfma_f32_16x16x32_bf16 v[120:123], v[12:15], v[40:43], v[120:123]
  ds_read_b64_tr_b16 v[38:39], v5 offset:1600
  s_cselect_b32 s48, 0, s48
  v_mfma_f32_16x16x32_bf16 v[124:127], v[16:19], v[40:43], v[124:127]
  ds_read_b64_tr_b16 v[40:41], v6 offset:0
  s_cselect_b32 s49, -123264, s53
  s_waitcnt lgkmcnt(9)
  v_mfma_f32_16x16x32_bf16 v[128:131], v[12:15], v[44:47], v[128:131]
  ds_read_b64_tr_b16 v[42:43], v6 offset:256
  v_add_u32 v2, s49, v2
  v_mfma_f32_16x16x32_bf16 v[132:135], v[16:19], v[44:47], v[132:135]
  ds_read_b64_tr_b16 v[44:45], v7 offset:0
  s_waitcnt lgkmcnt(8)
  v_mfma_f32_16x16x32_bf16 v[136:139], v[12:15], v[28:31], v[136:139]
  ds_read_b64_tr_b16 v[46:47], v7 offset:256
  v_add_u32 v3, s49, v3
  v_mfma_f32_16x16x32_bf16 v[140:143], v[16:19], v[28:31], v[140:143]
  ds_read_b64_tr_b16 v[28:29], v4 offset:4096
  s_waitcnt lgkmcnt(7)
  v_mfma_f32_16x16x32_bf16 v[144:147], v[12:15], v[32:35], v[144:147]
  ds_read_b64_tr_b16 v[30:31], v4 offset:4608
  v_mfma_f32_16x16x32_bf16 v[148:151], v[16:19], v[32:35], v[148:151]
  ds_read_b64_tr_b16 v[32:33], v5 offset:4096
  s_waitcnt lgkmcnt(7)
  v_mfma_f32_16x16x32_bf16 v[152:155], v[12:15], v[36:39], v[152:155]
  ds_read_b64_tr_b16 v[34:35], v5 offset:4608
  v_mfma_f32_16x16x32_bf16 v[156:159], v[16:19], v[36:39], v[156:159]
  ds_read_b64_tr_b16 v[36:37], v4 offset:4160
  s_waitcnt lgkmcnt(7)
  v_mfma_f32_16x16x32_bf16 v[160:163], v[12:15], v[40:43], v[160:163]
  ds_read_b64_tr_b16 v[38:39], v4 offset:4672
  v_mfma_f32_16x16x32_bf16 v[164:167], v[16:19], v[40:43], v[164:167]
  ds_read_b64_tr_b16 v[40:41], v5 offset:4160
  s_waitcnt lgkmcnt(7)
  v_mfma_f32_16x16x32_bf16 v[168:171], v[12:15], v[44:47], v[168:171]
  ds_read_b64_tr_b16 v[42:43], v5 offset:4672
  v_mfma_f32_16x16x32_bf16 v[172:175], v[16:19], v[44:47], v[172:175]
  ds_read_b64_tr_b16 v[44:45], v4 offset:5120
  s_waitcnt lgkmcnt(7)
  v_mfma_f32_16x16x32_bf16 v[96:99], v[20:23], v[28:31], v[96:99]
  ds_read_b64_tr_b16 v[46:47], v4 offset:5632
  v_mfma_f32_16x16x32_bf16 v[100:103], v[24:27], v[28:31], v[100:103]
  ds_read_b64_tr_b16 v[28:29], v5 offset:5120
  s_waitcnt lgkmcnt(7)
  v_mfma_f32_16x16x32_bf16 v[104:107], v[20:23], v[32:35], v[104:107]
  ds_read_b64_tr_b16 v[30:31], v5 offset:5632
  v_mfma_f32_16x16x32_bf16 v[108:111], v[24:27], v[32:35], v[108:111]
  ds_read_b64_tr_b16 v[32:33], v4 offset:5184
  s_waitcnt lgkmcnt(7)
  v_mfma_f32_16x16x32_bf16 v[112:115], v[20:23], v[36:39], v[112:115]
  ds_read_b64_tr_b16 v[34:35], v4 offset:5696
  v_mfma_f32_16x16x32_bf16 v[116:119], v[24:27], v[36:39], v[116:119]
  ds_read_b64_tr_b16 v[36:37], v5 offset:5184
  s_waitcnt lgkmcnt(7)
  v_mfma_f32_16x16x32_bf16 v[120:123], v[20:23], v[40:43], v[120:123]
  ds_read_b64_tr_b16 v[38:39], v5 offset:5696
  v_mfma_f32_16x16x32_bf16 v[124:127], v[24:27], v[40:43], v[124:127]
  ds_read_b64_tr_b16 v[40:41], v6 offset:2048
  s_waitcnt lgkmcnt(7)
  v_mfma_f32_16x16x32_bf16 v[128:131], v[20:23], v[44:47], v[128:131]
  ds_read_b64_tr_b16 v[42:43], v6 offset:2304
  v_mfma_f32_16x16x32_bf16 v[132:135], v[24:27], v[44:47], v[132:135]
  ds_read_b64_tr_b16 v[44:45], v7 offset:2048
  s_waitcnt lgkmcnt(7)
  v_mfma_f32_16x16x32_bf16 v[136:139], v[20:23], v[28:31], v[136:139]
  ds_read_b64_tr_b16 v[46:47], v7 offset:2304
  v_mfma_f32_16x16x32_bf16 v[140:143], v[24:27], v[28:31], v[140:143]
  v_add_u32 v4, s49, v4
  v_add_u32 v5, s49, v5
  s_waitcnt lgkmcnt(6)
  v_mfma_f32_16x16x32_bf16 v[144:147], v[20:23], v[32:35], v[144:147]
  v_add_u32 v6, s49, v6
  v_add_u32 v7, s49, v7
  v_mfma_f32_16x16x32_bf16 v[148:151], v[24:27], v[32:35], v[148:151]
  s_cmp_eq_u32 s50, 0
  s_cbranch_scc1 L_p2_b0
  buffer_load_dwordx4 v[68:71], v1, s[28:31], s55 offen sc1
  buffer_load_dwordx4 v[72:75], v1, s[28:31], s55 offen offset:1024 sc1
L_p2_b0:
  s_waitcnt lgkmcnt(0)
  s_barrier
  ds_read_b128 v[12:15], v2 offset:0
  ds_read_b128 v[16:19], v2 offset:2048
  ds_read_b64_tr_b16 v[28:29], v4 offset:0
  ds_read_b64_tr_b16 v[30:31], v4 offset:512
  v_mfma_f32_16x16x32_bf16 v[152:155], v[20:23], v[36:39], v[152:155]
  ds_read_b64_tr_b16 v[32:33], v5 offset:0
  ds_read_b64_tr_b16 v[34:35], v5 offset:512
  v_mfma_f32_16x16x32_bf16 v[156:159], v[24:27], v[36:39], v[156:159]
  ds_read_b64_tr_b16 v[36:37], v4 offset:64
  v_mfma_f32_16x16x32_bf16 v[160:163], v[20:23], v[40:43], v[160:163]
  ds_read_b64_tr_b16 v[38:39], v4 offset:576
  v_mfma_f32_16x16x32_bf16 v[164:167], v[24:27], v[40:43], v[164:167]
  ds_read_b64_tr_b16 v[40:41], v5 offset:64
  v_mfma_f32_16x16x32_bf16 v[168:171], v[20:23], v[44:47], v[168:171]
  ds_read_b64_tr_b16 v[42:43], v5 offset:576
  v_mfma_f32_16x16x32_bf16 v[172:175], v[24:27], v[44:47], v[172:175]
  ds_read_b64_tr_b16 v[44:45], v4 offset:1024
  s_waitcnt vmcnt(2)
  s_waitcnt lgkmcnt(7)
  v_mfma_f32_16x16x32_bf16 v[96:99], v[12:15], v[28:31], v[96:99]
  ds_read_b64_tr_b16 v[46:47], v4 offset:1536
  v_xor_b32 v8, v60, v52
  v_mfma_f32_16x16x32_bf16 v[100:103], v[16:19], v[28:31], v[100:103]
  ds_read_b64_tr_b16 v[28:29], v5 offset:1024
  ds_read_b128 v[20:23], v3 offset:0
  s_waitcnt lgkmcnt(8)
  v_mfma_f32_16x16x32_bf16 v[104:107], v[12:15], v[32:35], v[104:107]
  ds_read_b64_tr_b16 v[30:31], v5 offset:1536
  v_and_b32 v60, s57, v60
  v_mfma_f32_16x16x32_bf16 v[108:111], v[16:19], v[32:35], v[108:111]
  ds_read_b64_tr_b16 v[32:33], v4 offset:1088
  ds_read_b128 v[24:27], v3 offset:2048
  s_waitcnt lgkmcnt(9)
  v_mfma_f32_16x16x32_bf16 v[112:115], v[12:15], v[36:39], v[112:115]
  ds_read_b64_tr_b16 v[34:35], v4 offset:1600
  s_add_u32 s48, s48, 41088
  v_mfma_f32_16x16x32_bf16 v[116:119], v[16:19], v[36:39], v[116:119]
  ds_read_b64_tr_b16 v[36:37], v5 offset:1088
  s_cmp_eq_u32 s48, 164352
  s_waitcnt lgkmcnt(9)
  v_mfma_f32_16x16x32_bf16 v[120:123], v[12:15], v[40:43], v[120:123]
  ds_read_b64_tr_b16 v[38:39], v5 offset:1600
  s_cselect_b32 s48, 0, s48
  v_mfma_f32_16x16x32_bf16 v[124:127], v[16:19], v[40:43], v[124:127]
  ds_read_b64_tr_b16 v[40:41], v6 offset:0
  s_cselect_b32 s49, -123264, s53
  s_waitcnt lgkmcnt(9)
  v_mfma_f32_16x16x32_bf16 v[128:131], v[12:15], v[44:47], v[128:131]
  ds_read_b64_tr_b16 v[42:43], v6 offset:256
  v_add_u32 v2, s49, v2
  v_mfma_f32_16x16x32_bf16 v[132:135], v[16:19], v[44:47], v[132:135]
  ds_read_b64_tr_b16 v[44:45], v7 offset:0
  s_waitcnt lgkmcnt(8)
  v_mfma_f32_16x16x32_bf16 v[136:139], v[12:15], v[28:31], v[136:139]
  ds_read_b64_tr_b16 v[46:47], v7 offset:256
  v_add_u32 v3, s49, v3
  v_mfma_f32_16x16x32_bf16 v[140:143], v[16:19], v[28:31], v[140:143]
  ds_read_b64_tr_b16 v[28:29], v4 offset:4096
  s_waitcnt lgkmcnt(7)
  v_mfma_f32_16x16x32_bf16 v[144:147], v[12:15], v[32:35], v[144:147]
  ds_read_b64_tr_b16 v[30:31], v4 offset:4608
  v_bitop3_b32 v8, v8, v61, v53 bitop3:0xf6
  v_mfma_f32_16x16x32_bf16 v[148:151], v[16:19], v[32:35], v[148:151]
  ds_read_b64_tr_b16 v[32:33], v5 offset:4096
  s_waitcnt lgkmcnt(7)
  v_mfma_f32_16x16x32_bf16 v[152:155], v[12:15], v[36:39], v[152:155]
  ds_read_b64_tr_b16 v[34:35], v5 offset:4608
  v_and_b32 v61, s57, v61
  v_mfma_f32_16x16x32_bf16 v[156:159], v[16:19], v[36:39], v[156:159]
  ds_read_b64_tr_b16 v[36:37], v4 offset:4160
  s_waitcnt lgkmcnt(7)
  v_mfma_f32_16x16x32_bf16 v[160:163], v[12:15], v[40:43], v[160:163]
  ds_read_b64_tr_b16 v[38:39], v4 offset:4672
  v_bitop3_b32 v8, v8, v62, v54 bitop3:0xf6
  v_mfma_f32_16x16x32_bf16 v[164:167], v[16:19], v[40:43], v[164:167]
  ds_read_b64_tr_b16 v[40:41], v5 offset:4160
  s_waitcnt lgkmcnt(7)
  v_mfma_f32_16x16x32_bf16 v[168:171], v[12:15], v[44:47], v[168:171]
  ds_read_b64_tr_b16 v[42:43], v5 offset:4672
  v_and_b32 v62, s57, v62
  v_mfma_f32_16x16x32_bf16 v[172:175], v[16:19], v[44:47], v[172:175]
  ds_read_b64_tr_b16 v[44:45], v4 offset:5120
  s_waitcnt lgkmcnt(7)
  v_mfma_f32_16x16x32_bf16 v[96:99], v[20:23], v[28:31], v[96:99]
  ds_read_b64_tr_b16 v[46:47], v4 offset:5632
  v_bitop3_b32 v8, v8, v63, v55 bitop3:0xf6
  v_mfma_f32_16x16x32_bf16 v[100:103], v[24:27], v[28:31], v[100:103]
  ds_read_b64_tr_b16 v[28:29], v5 offset:5120
  s_waitcnt lgkmcnt(7)
  v_mfma_f32_16x16x32_bf16 v[104:107], v[20:23], v[32:35], v[104:107]
  ds_read_b64_tr_b16 v[30:31], v5 offset:5632
  v_and_b32 v63, s57, v63
  v_mfma_f32_16x16x32_bf16 v[108:111], v[24:27], v[32:35], v[108:111]
  ds_read_b64_tr_b16 v[32:33], v4 offset:5184
  s_waitcnt lgkmcnt(7)
  v_mfma_f32_16x16x32_bf16 v[112:115], v[20:23], v[36:39], v[112:115]
  ds_read_b64_tr_b16 v[34:35], v4 offset:5696
  v_bitop3_b32 v8, v8, v64, v52 bitop3:0xf6
  v_mfma_f32_16x16x32_bf16 v[116:119], v[24:27], v[36:39], v[116:119]
  ds_read_b64_tr_b16 v[36:37], v5 offset:5184
  s_waitcnt lgkmcnt(7)
  v_mfma_f32_16x16x32_bf16 v[120:123], v[20:23], v[40:43], v[120:123]
  ds_read_b64_tr_b16 v[38:39], v5 offset:5696
  v_and_b32 v64, s57, v64
  v_mfma_f32_16x16x32_bf16 v[124:127], v[24:27], v[40:43], v[124:127]
  ds_read_b64_tr_b16 v[40:41], v6 offset:2048
  s_waitcnt lgkmcnt(7)
  v_mfma_f32_16x16x32_bf16 v[128:131], v[20:23], v[44:47], v[128:131]
  ds_read_b64_tr_b16 v[42:43], v6 offset:2304
  v_bitop3_b32 v8, v8, v65, v53 bitop3:0xf6
  v_mfma_f32_16x16x32_bf16 v[132:135], v[24:27], v[44:47], v[132:135]
  ds_read_b64_tr_b16 v[44:45], v7 offset:2048
  s_waitcnt lgkmcnt(7)
  v_mfma_f32_16x16x32_bf16 v[136:139], v[20:23], v[28:31], v[136:139]
  ds_read_b64_tr_b16 v[46:47], v7 offset:2304
  v_and_b32 v65, s57, v65
  v_mfma_f32_16x16x32_bf16 v[140:143], v[24:27], v[28:31], v[140:143]
  v_add_u32 v4, s49, v4
  v_add_u32 v5, s49, v5
  s_waitcnt lgkmcnt(6)
  v_mfma_f32_16x16x32_bf16 v[144:147], v[20:23], v[32:35], v[144:147]
  v_add_u32 v6, s49, v6
  v_add_u32 v7, s49, v7
  v_mfma_f32_16x16x32_bf16 v[148:151], v[24:27], v[32:35], v[148:151]
  s_waitcnt lgkmcnt(0)
  s_barrier
  ds_read_b128 v[12:15], v2 offset:0
  ds_read_b128 v[16:19], v2 offset:2048
  ds_read_b64_tr_b16 v[28:29], v4 offset:0
  ds_read_b64_tr_b16 v[30:31], v4 offset:512
  v_mfma_f32_16x16x32_bf16 v[152:155], v[20:23], v[36:39], v[152:155]
  ds_read_b64_tr_b16 v[32:33], v5 offset:0
  ds_read_b64_tr_b16 v[34:35], v5 offset:512
  v_bitop3_b32 v8, v8, v66, v54 bitop3:0xf6
  v_mfma_f32_16x16x32_bf16 v[156:159], v[24:27], v[36:39], v[156:159]
  ds_read_b64_tr_b16 v[36:37], v4 offset:64
  v_mfma_f32_16x16x32_bf16 v[160:163], v[20:23], v[40:43], v[160:163]
  ds_read_b64_tr_b16 v[38:39], v4 offset:576
  v_and_b32 v66, s57, v66
  v_mfma_f32_16x16x32_bf16 v[164:167], v[24:27], v[40:43], v[164:167]
  ds_read_b64_tr_b16 v[40:41], v5 offset:64
  v_bitop3_b32 v8, v8, v67, v55 bitop3:0xf6
  v_mfma_f32_16x16x32_bf16 v[168:171], v[20:23], v[44:47], v[168:171]
  ds_read_b64_tr_b16 v[42:43], v5 offset:576
  v_and_b32 v67, s57, v67
  v_mfma_f32_16x16x32_bf16 v[172:175], v[24:27], v[44:47], v[172:175]
  ds_read_b64_tr_b16 v[44:45], v4 offset:1024
  v_and_b32 v8, s56, v8
  s_cmp_eq_u32 s50, 1
  s_cbranch_scc1 L_p2_pm0
  s_cmp_eq_u32 s50, 2
  s_cbranch_scc1 L_p2_last
  v_cvt_pk_bf16_f32 v224, v96, v97
  v_cvt_pk_bf16_f32 v225, v98, v99
  v_cvt_pk_bf16_f32 v226, v100, v101
  v_cvt_pk_bf16_f32 v227, v102, v103
  v_cvt_pk_bf16_f32 v228, v104, v105
  v_cvt_pk_bf16_f32 v229, v106, v107
  v_cvt_pk_bf16_f32 v230, v108, v109
  v_cvt_pk_bf16_f32 v231, v110, v111
  v_cvt_pk_bf16_f32 v232, v112, v113
  v_cvt_pk_bf16_f32 v233, v114, v115
  v_cvt_pk_bf16_f32 v234, v116, v117
  v_cvt_pk_bf16_f32 v235, v118, v119
  v_cvt_pk_bf16_f32 v236, v120, v121
  v_cvt_pk_bf16_f32 v237, v122, v123
  v_cvt_pk_bf16_f32 v238, v124, v125
  v_cvt_pk_bf16_f32 v239, v126, v127
  v_cvt_pk_bf16_f32 v240, v128, v129
  v_cvt_pk_bf16_f32 v241, v130, v131
  v_cvt_pk_bf16_f32 v242, v132, v133
  v_cvt_pk_bf16_f32 v243, v134, v135
  v_cvt_pk_bf16_f32 v244, v136, v137
  v_cvt_pk_bf16_f32 v245, v138, v139
  v_cvt_pk_bf16_f32 v246, v140, v141
  v_cvt_pk_bf16_f32 v247, v142, v143
  v_cvt_pk_bf16_f32 v248, v144, v145
  v_cvt_pk_bf16_f32 v249, v146, v147
  v_cvt_pk_bf16_f32 v250, v148, v149
  v_cvt_pk_bf16_f32 v251, v150, v151
  v_cvt_pk_bf16_f32 v252, v152, v153
  v_cvt_pk_bf16_f32 v253, v154, v155
  v_cvt_pk_bf16_f32 v254, v156, v157
  v_cvt_pk_bf16_f32 v255, v158, v159
  v_cvt_pk_bf16_f32 v76, v160, v161
  v_cvt_pk_bf16_f32 v77, v162, v163
  v_cvt_pk_bf16_f32 v78, v164, v165
  v_cvt_pk_bf16_f32 v79, v166, v167
  v_cvt_pk_bf16_f32 v80, v168, v169
  v_cvt_pk_bf16_f32 v81, v170, v171
  v_cvt_pk_bf16_f32 v82, v172, v173
  v_cvt_pk_bf16_f32 v83, v174, v175
  s_mov_b32 s50, 1
  s_branch L_p2
L_p2_pm0:
  v_cmp_ne_u32 vcc, 0, v8
  s_cbranch_vccnz L_s0
L_s0_ok:
  s_waitcnt vmcnt(0)
  v_mfma_f32_16x16x32_bf16 v[176:179], v[224:227], v[60:63], 0
  v_xor_b32 v9, v68, v52
  v_and_b32 v68, s57, v68
  v_mfma_f32_16x16x32_bf16 v[184:187], v[224:227], v[64:67], 0
  v_bitop3_b32 v9, v9, v69, v53 bitop3:0xf6
  v_and_b32 v69, s57, v69
  v_mfma_f32_16x16x32_bf16 v[180:183], v[228:231], v[60:63], 0
  v_bitop3_b32 v9, v9, v70, v54 bitop3:0xf6
  v_and_b32 v70, s57, v70
  v_mfma_f32_16x16x32_bf16 v[188:191], v[228:231], v[64:67], 0
  v_bitop3_b32 v9, v9, v71, v55 bitop3:0xf6
  v_and_b32 v71, s57, v71
  v_mfma_f32_16x16x32_bf16 v[192:195], v[232:235], v[60:63], 0
  v_bitop3_b32 v9, v9, v72, v52 bitop3:0xf6
  v_and_b32 v72, s57, v72
  v_mfma_f32_16x16x32_bf16 v[200:203], v[232:235], v[64:67], 0
  v_bitop3_b32 v9, v9, v73, v53 bitop3:0xf6
  v_and_b32 v73, s57, v73
  v_mfma_f32_16x16x32_bf16 v[196:199], v[236:239], v[60:63], 0
  v_bitop3_b32 v9, v9, v74, v54 bitop3:0xf6
  v_and_b32 v74, s57, v74
  v_mfma_f32_16x16x32_bf16 v[204:207], v[236:239], v[64:67], 0
  v_bitop3_b32 v9, v9, v75, v55 bitop3:0xf6
  v_and_b32 v75, s57, v75
  v_mfma_f32_16x16x32_bf16 v[208:211], v[240:243], v[60:63], 0
  v_and_b32 v9, s56, v9
  v_mfma_f32_16x16x32_bf16 v[216:219], v[240:243], v[64:67], 0
  v_mfma_f32_16x16x32_bf16 v[212:215], v[244:247], v[60:63], 0
  v_mfma_f32_16x16x32_bf16 v[220:223], v[244:247], v[64:67], 0
  v_mfma_f32_16x16x32_bf16 v[224:227], v[248:251], v[60:63], 0
  v_cvt_pk_bf16_f32 v84, v96, v97
  v_cvt_pk_bf16_f32 v85, v98, v99
  v_mfma_f32_16x16x32_bf16 v[232:235], v[248:251], v[64:67], 0
  v_cvt_pk_bf16_f32 v86, v100, v101
  v_cvt_pk_bf16_f32 v87, v102, v103
  v_mfma_f32_16x16x32_bf16 v[228:231], v[252:255], v[60:63], 0
  v_cvt_pk_bf16_f32 v88, v104, v105
  v_cvt_pk_bf16_f32 v89, v106, v107
  v_mfma_f32_16x16x32_bf16 v[236:239], v[252:255], v[64:67], 0
  v_cvt_pk_bf16_f32 v90, v108, v109
  v_cvt_pk_bf16_f32 v91, v110, v111
  v_mfma_f32_16x16x32_bf16 v[240:243], v[76:79], v[60:63], 0
  v_mfma_f32_16x16x32_bf16 v[248:251], v[76:79], v[64:67], 0
  v_mfma_f32_16x16x32_bf16 v[244:247], v[80:83], v[60:63], 0
  v_mfma_f32_16x16x32_bf16 v[252:255], v[80:83], v[64:67], 0
  v_cmp_ne_u32 vcc, 0, v9
  s_cbranch_vccnz L_s1
L_s1_ok:
  v_mfma_f32_16x16x32_bf16 v[176:179], v[84:87], v[68:71], v[176:179]
  v_cvt_pk_bf16_f32 v76, v112, v113
  v_cvt_pk_bf16_f32 v77, v114, v115
  v_mfma_f32_16x16x32_bf16 v[184:187], v[84:87], v[72:75], v[184:187]
  v_cvt_pk_bf16_f32 v78, v116, v117
  v_cvt_pk_bf16_f32 v79, v118, v119
  v_mfma_f32_16x16x32_bf16 v[180:183], v[88:91], v[68:71], v[180:183]
  v_cvt_pk_bf16_f32 v80, v120, v121
  v_cvt_pk_bf16_f32 v81, v122, v123
  v_mfma_f32_16x16x32_bf16 v[188:191], v[88:91], v[72:75], v[188:191]
  v_cvt_pk_bf16_f32 v82, v124, v125
  v_cvt_pk_bf16_f32 v83, v126, v127
  v_mfma_f32_16x16x32_bf16 v[192:195], v[76:79], v[68:71], v[192:195]
  v_cvt_pk_bf16_f32 v84, v128, v129
  v_cvt_pk_bf16_f32 v85, v130, v131
  v_mfma_f32_16x16x32_bf16 v[200:203], v[76:79], v[72:75], v[200:203]
  v_cvt_pk_bf16_f32 v86, v132, v133
  v_cvt_pk_bf16_f32 v87, v134, v135
  v_mfma_f32_16x16x32_bf16 v[196:199], v[80:83], v[68:71], v[196:199]
  v_cvt_pk_bf16_f32 v88, v136, v137
  v_cvt_pk_bf16_f32 v89, v138, v139
  v_mfma_f32_16x16x32_bf16 v[204:207], v[80:83], v[72:75], v[204:207]
  v_cvt_pk_bf16_f32 v90, v140, v141
  v_cvt_pk_bf16_f32 v91, v142, v143
  v_mfma_f32_16x16x32_bf16 v[208:211], v[84:87], v[68:71], v[208:211]
  v_cvt_pk_bf16_f32 v76, v144, v145
  v_cvt_pk_bf16_f32 v77, v146, v147
  v_mfma_f32_16x16x32_bf16 v[216:219], v[84:87], v[72:75], v[216:219]
  v_cvt_pk_bf16_f32 v78, v148, v149
  v_cvt_pk_bf16_f32 v79, v150, v151
  v_mfma_f32_16x16x32_bf16 v[212:215], v[88:91], v[68:71], v[212:215]
  v_cvt_pk_bf16_f32 v80, v152, v153
  v_cvt_pk_bf16_f32 v81, v154, v155
  v_mfma_f32_16x16x32_bf16 v[220:223], v[88:91], v[72:75], v[220:223]
  v_cvt_pk_bf16_f32 v82, v156, v157
  v_cvt_pk_bf16_f32 v83, v158, v159
  v_mfma_f32_16x16x32_bf16 v[224:227], v[76:79], v[68:71], v[224:227]
  v_cvt_pk_bf16_f32 v84, v160, v161
  v_cvt_pk_bf16_f32 v85, v162, v163
  v_mfma_f32_16x16x32_bf16 v[232:235], v[76:79], v[72:75], v[232:235]
  v_cvt_pk_bf16_f32 v86, v164, v165
  v_cvt_pk_bf16_f32 v87, v166, v167
  v_mfma_f32_16x16x32_bf16 v[228:231], v[80:83], v[68:71], v[228:231]
  v_cvt_pk_bf16_f32 v88, v168, v169
  v_cvt_pk_bf16_f32 v89, v170, v171
  v_mfma_f32_16x16x32_bf16 v[236:239], v[80:83], v[72:75], v[236:239]
  v_cvt_pk_bf16_f32 v90, v172, v173
  v_cvt_pk_bf16_f32 v91, v174, v175
  v_mfma_f32_16x16x32_bf16 v[240:243], v[84:87], v[68:71], v[240:243]
  v_mfma_f32_16x16x32_bf16 v[248:251], v[84:87], v[72:75], v[248:251]
  v_mfma_f32_16x16x32_bf16 v[244:247], v[88:91], v[68:71], v[244:247]
  v_mfma_f32_16x16x32_bf16 v[252:255], v[88:91], v[72:75], v[252:255]
  s_mov_b32 s50, 2
L_p2:
  s_waitcnt lgkmcnt(7)
  v_mfma_f32_16x16x32_bf16 v[96:99], v[12:15], v[28:31], 0
  ds_read_b64_tr_b16 v[46:47], v4 offset:1536
  v_mfma_f32_16x16x32_bf16 v[100:103], v[16:19], v[28:31], 0
  ds_read_b64_tr_b16 v[28:29], v5 offset:1024
  ds_read_b128 v[20:23], v3 offset:0
  s_waitcnt lgkmcnt(8)
  v_mfma_f32_16x16x32_bf16 v[104:107], v[12:15], v[32:35], 0
  ds_read_b64_tr_b16 v[30:31], v5 offset:1536
  v_mfma_f32_16x16x32_bf16 v[108:111], v[16:19], v[32:35], 0
  ds_read_b64_tr_b16 v[32:33], v4 offset:1088
  ds_read_b128 v[24:27], v3 offset:2048
  s_waitcnt lgkmcnt(9)
  v_mfma_f32_16x16x32_bf16 v[112:115], v[12:15], v[36:39], 0
  ds_read_b64_tr_b16 v[34:35], v4 offset:1600
  s_add_u32 s48, s48, 41088
  v_mfma_f32_16x16x32_bf16 v[116:119], v[16:19], v[36:39], 0
  ds_read_b64_tr_b16 v[36:37], v5 offset:1088
  s_cmp_eq_u32 s48, 164352
  s_waitcnt lgkmcnt(9)
  v_mfma_f32_16x16x32_bf16 v[120:123], v[12:15], v[40:43], 0
  ds_read_b64_tr_b16 v[38:39], v5 offset:1600
  s_cselect_b32 s48, 0, s48
  v_mfma_f32_16x16x32_bf16 v[124:127], v[16:19], v[40:43], 0
  ds_read_b64_tr_b16 v[40:41], v6 offset:0
  s_cselect_b32 s49, -123264, s53
  s_waitcnt lgkmcnt(9)
  v_mfma_f32_16x16x32_bf16 v[128:131], v[12:15], v[44:47], 0
  ds_read_b64_tr_b16 v[42:43], v6 offset:256
  v_add_u32 v2, s49, v2
  v_mfma_f32_16x16x32_bf16 v[132:135], v[16:19], v[44:47], 0
  ds_read_b64_tr_b16 v[44:45], v7 offset:0
  s_waitcnt lgkmcnt(8)
  v_mfma_f32_16x16x32_bf16 v[136:139], v[12:15], v[28:31], 0
  ds_read_b64_tr_b16 v[46:47], v7 offset:256
  v_add_u32 v3, s49, v3
  v_mfma_f32_16x16x32_bf16 v[140:143], v[16:19], v[28:31], 0
  ds_read_b64_tr_b16 v[28:29], v4 offset:4096
  s_waitcnt lgkmcnt(7)
  v_mfma_f32_16x16x32_bf16 v[144:147], v[12:15], v[32:35], 0
  ds_read_b64_tr_b16 v[30:31], v4 offset:4608
  s_cmp_eq_u32 s50, 1
  s_cselect_b64 s[54:55], s[72:73], s[74:75]
  v_mfma_f32_16x16x32_bf16 v[148:151], v[16:19], v[32:35], 0
  ds_read_b64_tr_b16 v[32:33], v5 offset:4096
  s_waitcnt lgkmcnt(7)
  v_mfma_f32_16x16x32_bf16 v[152:155], v[12:15], v[36:39], 0
  ds_read_b64_tr_b16 v[34:35], v5 offset:4608
  v_mfma_f32_16x16x32_bf16 v[156:159], v[16:19], v[36:39], 0
  ds_read_b64_tr_b16 v[36:37], v4 offset:4160
  s_waitcnt lgkmcnt(7)
  v_mfma_f32_16x16x32_bf16 v[160:163], v[12:15], v[40:43], 0
  ds_read_b64_tr_b16 v[38:39], v4 offset:4672
  v_mfma_f32_16x16x32_bf16 v[164:167], v[16:19], v[40:43], 0
  ds_read_b64_tr_b16 v[40:41], v5 offset:4160
  s_waitcnt lgkmcnt(7)
  v_mfma_f32_16x16x32_bf16 v[168:171], v[12:15], v[44:47], 0
  ds_read_b64_tr_b16 v[42:43], v5 offset:4672
  v_mfma_f32_16x16x32_bf16 v[172:175], v[16:19], v[44:47], 0
  ds_read_b64_tr_b16 v[44:45], v4 offset:5120
  s_waitcnt lgkmcnt(7)
  v_mfma_f32_16x16x32_bf16 v[96:99], v[20:23], v[28:31], v[96:99]
  ds_read_b64_tr_b16 v[46:47], v4 offset:5632
  v_mfma_f32_16x16x32_bf16 v[100:103], v[24:27], v[28:31], v[100:103]
  ds_read_b64_tr_b16 v[28:29], v5 offset:5120
  s_waitcnt lgkmcnt(7)
  v_mfma_f32_16x16x32_bf16 v[104:107], v[20:23], v[32:35], v[104:107]
  ds_read_b64_tr_b16 v[30:31], v5 offset:5632
  v_mfma_f32_16x16x32_bf16 v[108:111], v[24:27], v[32:35], v[108:111]
  ds_read_b64_tr_b16 v[32:33], v4 offset:5184
  s_waitcnt lgkmcnt(7)
  v_mfma_f32_16x16x32_bf16 v[112:115], v[20:23], v[36:39], v[112:115]
  ds_read_b64_tr_b16 v[34:35], v4 offset:5696
  v_mfma_f32_16x16x32_bf16 v[116:119], v[24:27], v[36:39], v[116:119]
  ds_read_b64_tr_b16 v[36:37], v5 offset:5184
  s_waitcnt lgkmcnt(7)
  v_mfma_f32_16x16x32_bf16 v[120:123], v[20:23], v[40:43], v[120:123]
  ds_read_b64_tr_b16 v[38:39], v5 offset:5696
  v_mfma_f32_16x16x32_bf16 v[124:127], v[24:27], v[40:43], v[124:127]
  ds_read_b64_tr_b16 v[40:41], v6 offset:2048
  s_waitcnt lgkmcnt(7)
  v_mfma_f32_16x16x32_bf16 v[128:131], v[20:23], v[44:47], v[128:131]
  ds_read_b64_tr_b16 v[42:43], v6 offset:2304
  v_mfma_f32_16x16x32_bf16 v[132:135], v[24:27], v[44:47], v[132:135]
  ds_read_b64_tr_b16 v[44:45], v7 offset:2048
  s_waitcnt lgkmcnt(7)
  v_mfma_f32_16x16x32_bf16 v[136:139], v[20:23], v[28:31], v[136:139]
  ds_read_b64_tr_b16 v[46:47], v7 offset:2304
  v_mfma_f32_16x16x32_bf16 v[140:143], v[24:27], v[28:31], v[140:143]
  v_add_u32 v4, s49, v4
  v_add_u32 v5, s49, v5
  s_waitcnt lgkmcnt(6)
  v_mfma_f32_16x16x32_bf16 v[144:147], v[20:23], v[32:35], v[144:147]
  v_add_u32 v6, s49, v6
  v_add_u32 v7, s49, v7
  v_mfma_f32_16x16x32_bf16 v[148:151], v[24:27], v[32:35], v[148:151]
  buffer_load_dwordx4 v[60:63], v1, s[28:31], s54 offen sc1
  buffer_load_dwordx4 v[64:67], v1, s[28:31], s54 offen offset:1024 sc1
  s_waitcnt lgkmcnt(0)
  s_barrier
  ds_read_b128 v[12:15], v2 offset:0
  ds_read_b128 v[16:19], v2 offset:2048
  ds_read_b64_tr_b16 v[28:29], v4 offset:0
  ds_read_b64_tr_b16 v[30:31], v4 offset:512
  v_mfma_f32_16x16x32_bf16 v[152:155], v[20:23], v[36:39], v[152:155]
  ds_read_b64_tr_b16 v[32:33], v5 offset:0
  ds_read_b64_tr_b16 v[34:35], v5 offset:512
  v_mfma_f32_16x16x32_bf16 v[156:159], v[24:27], v[36:39], v[156:159]
  ds_read_b64_tr_b16 v[36:37], v4 offset:64
  v_mfma_f32_16x16x32_bf16 v[160:163], v[20:23], v[40:43], v[160:163]
  ds_read_b64_tr_b16 v[38:39], v4 offset:576
  v_mfma_f32_16x16x32_bf16 v[164:167], v[24:27], v[40:43], v[164:167]
  ds_read_b64_tr_b16 v[40:41], v5 offset:64
  v_mfma_f32_16x16x32_bf16 v[168:171], v[20:23], v[44:47], v[168:171]
  ds_read_b64_tr_b16 v[42:43], v5 offset:576
  v_mfma_f32_16x16x32_bf16 v[172:175], v[24:27], v[44:47], v[172:175]
  ds_read_b64_tr_b16 v[44:45], v4 offset:1024
  s_branch L_p2_b
L_p1_k:
  s_cmp_lg_u32 s50, 5
  s_cbranch_scc1 L_p1_k0
  s_waitcnt lgkmcnt(6)
  ds_read_b64 v[96:97], v92 offset:0
  ds_read_b64 v[98:99], v93 offset:0
  ds_read_b64 v[100:101], v92 offset:2048
  ds_read_b64 v[102:103], v93 offset:2048
  ds_read_b64 v[104:105], v94 offset:0
  ds_read_b64 v[106:107], v95 offset:0
  ds_read_b64 v[108:109], v94 offset:2048
  ds_read_b64 v[110:111], v95 offset:2048
  s_add_u32 s32, s32, 0x9e3779b9
  v_and_b32 v144, 3, v0
  v_lshlrev_b32 v144, 2, v144
  v_lshrrev_b32 v144, v144, s32
  v_lshrrev_b32 v52, 0, v144
  v_and_b32 v52, 0x10001, v52
  v_lshl_or_b32 v52, v52, 15, v52
  v_lshrrev_b32 v53, 1, v144
  v_and_b32 v53, 0x10001, v53
  v_lshl_or_b32 v53, v53, 15, v53
  v_lshrrev_b32 v54, 2, v144
  v_and_b32 v54, 0x10001, v54
  v_lshl_or_b32 v54, v54, 15, v54
  v_lshrrev_b32 v55, 3, v144
  v_and_b32 v55, 0x10001, v55
  v_lshl_or_b32 v55, v55, 15, v55
  s_branch L_p1_nk
L_p1_k0:
  s_waitcnt lgkmcnt(6)
  ds_read_b64 v[112:113], v92 offset:16384
  ds_read_b64 v[114:115], v93 offset:16384
  ds_read_b64 v[116:117], v92 offset:18432
  ds_read_b64 v[118:119], v93 offset:18432
  ds_read_b64 v[120:121], v94 offset:16384
  ds_read_b64 v[122:123], v95 offset:16384
  ds_read_b64 v[124:125], v94 offset:18432
  ds_read_b64 v[126:127], v95 offset:18432
  s_branch L_p1_nk
L_s0:
  s_mov_b32 s70, 200000
  s_mov_b32 s44, s72
L_s0_l:
  buffer_load_dwordx4 v[60:63], v1, s[28:31], s44 offen sc1
  buffer_load_dwordx4 v[64:67], v1, s[28:31], s44 offen offset:1024 sc1
  s_sub_u32 s70, s70, 1
  s_cmp_eq_u32 s70, 0
  s_waitcnt vmcnt(0)
  s_cbranch_scc1 L_s0_ok
  v_xor_b32 v8, v60, v52
  v_and_b32 v60, s57, v60
  v_bitop3_b32 v8, v8, v61, v53 bitop3:0xf6
  v_and_b32 v61, s57, v61
  v_bitop3_b32 v8, v8, v62, v54 bitop3:0xf6
  v_and_b32 v62, s57, v62
  v_bitop3_b32 v8, v8, v63, v55 bitop3:0xf6
  v_and_b32 v63, s57, v63
  v_bitop3_b32 v8, v8, v64, v52 bitop3:0xf6
  v_and_b32 v64, s57, v64
  v_bitop3_b32 v8, v8, v65, v53 bitop3:0xf6
  v_and_b32 v65, s57, v65
  v_bitop3_b32 v8, v8, v66, v54 bitop3:0xf6
  v_and_b32 v66, s57, v66
  v_bitop3_b32 v8, v8, v67, v55 bitop3:0xf6
  v_and_b32 v67, s57, v67
  v_and_b32 v8, s56, v8
  v_cmp_ne_u32 vcc, 0, v8
  s_cbranch_vccnz L_s0_l
  s_branch L_s0_ok
L_s1:
  s_mov_b32 s70, 200000
  s_mov_b32 s44, s73
L_s1_l:
  buffer_load_dwordx4 v[68:71], v1, s[28:31], s44 offen sc1
  buffer_load_dwordx4 v[72:75], v1, s[28:31], s44 offen offset:1024 sc1
  s_sub_u32 s70, s70, 1
  s_cmp_eq_u32 s70, 0
  s_waitcnt vmcnt(0)
  s_cbranch_scc1 L_s1_ok
  v_xor_b32 v9, v68, v52
  v_and_b32 v68, s57, v68
  v_bitop3_b32 v9, v9, v69, v53 bitop3:0xf6
  v_and_b32 v69, s57, v69
  v_bitop3_b32 v9, v9, v70, v54 bitop3:0xf6
  v_and_b32 v70, s57, v70
  v_bitop3_b32 v9, v9, v71, v55 bitop3:0xf6
  v_and_b32 v71, s57, v71
  v_bitop3_b32 v9, v9, v72, v52 bitop3:0xf6
  v_and_b32 v72, s57, v72
  v_bitop3_b32 v9, v9, v73, v53 bitop3:0xf6
  v_and_b32 v73, s57, v73
  v_bitop3_b32 v9, v9, v74, v54 bitop3:0xf6
  v_and_b32 v74, s57, v74
  v_bitop3_b32 v9, v9, v75, v55 bitop3:0xf6
  v_and_b32 v75, s57, v75
  v_and_b32 v9, s56, v9
  v_cmp_ne_u32 vcc, 0, v9
  s_cbranch_vccnz L_s1_l
  s_branch L_s1_ok
L_s2:
  s_mov_b32 s70, 200000
  s_mov_b32 s44, s74
L_s2_l:
  buffer_load_dwordx4 v[60:63], v1, s[28:31], s44 offen sc1
  buffer_load_dwordx4 v[64:67], v1, s[28:31], s44 offen offset:1024 sc1
  s_sub_u32 s70, s70, 1
  s_cmp_eq_u32 s70, 0
  s_waitcnt vmcnt(0)
  s_cbranch_scc1 L_s2_ok
  v_xor_b32 v8, v60, v52
  v_and_b32 v60, s57, v60
  v_bitop3_b32 v8, v8, v61, v53 bitop3:0xf6
  v_and_b32 v61, s57, v61
  v_bitop3_b32 v8, v8, v62, v54 bitop3:0xf6
  v_and_b32 v62, s57, v62
  v_bitop3_b32 v8, v8, v63, v55 bitop3:0xf6
  v_and_b32 v63, s57, v63
  v_bitop3_b32 v8, v8, v64, v52 bitop3:0xf6
  v_and_b32 v64, s57, v64
  v_bitop3_b32 v8, v8, v65, v53 bitop3:0xf6
  v_and_b32 v65, s57, v65
  v_bitop3_b32 v8, v8, v66, v54 bitop3:0xf6
  v_and_b32 v66, s57, v66
  v_bitop3_b32 v8, v8, v67, v55 bitop3:0xf6
  v_and_b32 v67, s57, v67
  v_and_b32 v8, s56, v8
  v_cmp_ne_u32 vcc, 0, v8
  s_cbranch_vccnz L_s2_l
  s_branch L_s2_ok
L_s3:
  s_mov_b32 s70, 200000
  s_mov_b32 s44, s75
L_s3_l:
  buffer_load_dwordx4 v[68:71], v1, s[28:31], s44 offen sc1
  buffer_load_dwordx4 v[72:75], v1, s[28:31], s44 offen offset:1024 sc1
  s_sub_u32 s70, s70, 1
  s_cmp_eq_u32 s70, 0
  s_waitcnt vmcnt(0)
  s_cbranch_scc1 L_s3_ok
  v_xor_b32 v9, v68, v52
  v_and_b32 v68, s57, v68
  v_bitop3_b32 v9, v9, v69, v53 bitop3:0xf6
  v_and_b32 v69, s57, v69
  v_bitop3_b32 v9, v9, v70, v54 bitop3:0xf6
  v_and_b32 v70, s57, v70
  v_bitop3_b32 v9, v9, v71, v55 bitop3:0xf6
  v_and_b32 v71, s57, v71
  v_bitop3_b32 v9, v9, v72, v52 bitop3:0xf6
  v_and_b32 v72, s57, v72
  v_bitop3_b32 v9, v9, v73, v53 bitop3:0xf6
  v_and_b32 v73, s57, v73
  v_bitop3_b32 v9, v9, v74, v54 bitop3:0xf6
  v_and_b32 v74, s57, v74
  v_bitop3_b32 v9, v9, v75, v55 bitop3:0xf6
  v_and_b32 v75, s57, v75
  v_and_b32 v9, s56, v9
  v_cmp_ne_u32 vcc, 0, v9
  s_cbranch_vccnz L_s3_l
  s_branch L_s3_ok
L_p2_last:
  v_cvt_pk_bf16_f32 v84, v96, v97
  v_cvt_pk_bf16_f32 v85, v98, v99
  v_cvt_pk_bf16_f32 v86, v100, v101
  v_cvt_pk_bf16_f32 v87, v102, v103
  v_cmp_ne_u32 vcc, 0, v8
  s_cbranch_vccnz L_s2
L_s2_ok:
  s_waitcnt lgkmcnt(5)
  v_mfma_f32_16x16x32_bf16 v[176:179], v[84:87], v[60:63], v[176:179]
  v_cvt_pk_bf16_f32 v88, v104, v105
  v_cvt_pk_bf16_f32 v89, v106, v107
  v_cvt_pk_bf16_f32 v76, v112, v113
  v_cvt_pk_bf16_f32 v77, v114, v115
  v_mfma_f32_16x16x32_bf16 v[184:187], v[84:87], v[64:67], v[184:187]
  v_cvt_pk_bf16_f32 v90, v108, v109
  v_cvt_pk_bf16_f32 v91, v110, v111
  v_cvt_pk_bf16_f32 v78, v116, v117
  v_cvt_pk_bf16_f32 v79, v118, v119
  v_mfma_f32_16x16x32_bf16 v[180:183], v[88:91], v[60:63], v[180:183]
  v_cvt_pk_bf16_f32 v80, v120, v121
  v_cvt_pk_bf16_f32 v81, v122, v123
  v_mfma_f32_16x16x32_bf16 v[188:191], v[88:91], v[64:67], v[188:191]
  v_cvt_pk_bf16_f32 v82, v124, v125
  v_cvt_pk_bf16_f32 v83, v126, v127
  v_mfma_f32_16x16x32_bf16 v[192:195], v[76:79], v[60:63], v[192:195]
  v_cvt_pk_bf16_f32 v84, v128, v129
  v_cvt_pk_bf16_f32 v85, v130, v131
  v_mfma_f32_16x16x32_bf16 v[200:203], v[76:79], v[64:67], v[200:203]
  v_cvt_pk_bf16_f32 v86, v132, v133
  v_cvt_pk_bf16_f32 v87, v134, v135
  v_mfma_f32_16x16x32_bf16 v[196:199], v[80:83], v[60:63], v[196:199]
  v_cvt_pk_bf16_f32 v88, v136, v137
  v_cvt_pk_bf16_f32 v89, v138, v139
  v_mfma_f32_16x16x32_bf16 v[204:207], v[80:83], v[64:67], v[204:207]
  v_cvt_pk_bf16_f32 v90, v140, v141
  v_cvt_pk_bf16_f32 v91, v142, v143
  v_mfma_f32_16x16x32_bf16 v[208:211], v[84:87], v[60:63], v[208:211]
  v_cvt_pk_bf16_f32 v76, v144, v145
  v_cvt_pk_bf16_f32 v77, v146, v147
  v_mfma_f32_16x16x32_bf16 v[216:219], v[84:87], v[64:67], v[216:219]
  v_cvt_pk_bf16_f32 v78, v148, v149
  v_cvt_pk_bf16_f32 v79, v150, v151
  v_mfma_f32_16x16x32_bf16 v[212:215], v[88:91], v[60:63], v[212:215]
  v_cvt_pk_bf16_f32 v80, v152, v153
  v_cvt_pk_bf16_f32 v81, v154, v155
  v_mfma_f32_16x16x32_bf16 v[220:223], v[88:91], v[64:67], v[220:223]
  v_cvt_pk_bf16_f32 v82, v156, v157
  v_cvt_pk_bf16_f32 v83, v158, v159
  v_mfma_f32_16x16x32_bf16 v[224:227], v[76:79], v[60:63], v[224:227]
  v_cvt_pk_bf16_f32 v84, v160, v161
  v_cvt_pk_bf16_f32 v85, v162, v163
  v_mfma_f32_16x16x32_bf16 v[232:235], v[76:79], v[64:67], v[232:235]
  v_cvt_pk_bf16_f32 v86, v164, v165
  v_cvt_pk_bf16_f32 v87, v166, v167
  v_mfma_f32_16x16x32_bf16 v[228:231], v[80:83], v[60:63], v[228:231]
  v_cvt_pk_bf16_f32 v88, v168, v169
  v_cvt_pk_bf16_f32 v89, v170, v171
  v_mfma_f32_16x16x32_bf16 v[236:239], v[80:83], v[64:67], v[236:239]
  v_cvt_pk_bf16_f32 v90, v172, v173
  v_cvt_pk_bf16_f32 v91, v174, v175
  v_mfma_f32_16x16x32_bf16 v[240:243], v[84:87], v[60:63], v[240:243]
  ds_read_b128 v[20:23], v3 offset:0
  ds_read_b64_tr_b16 v[36:37], v4 offset:4096
  v_mfma_f32_16x16x32_bf16 v[248:251], v[84:87], v[64:67], v[248:251]
  ds_read_b128 v[24:27], v3 offset:2048
  ds_read_b64_tr_b16 v[38:39], v4 offset:4608
  v_mfma_f32_16x16x32_bf16 v[244:247], v[88:91], v[60:63], v[244:247]
  ds_read_b64_tr_b16 v[40:41], v5 offset:4096
  ds_read_b64_tr_b16 v[42:43], v5 offset:4608
  v_mfma_f32_16x16x32_bf16 v[252:255], v[88:91], v[64:67], v[252:255]
  v_add_u32 v92, 82176, v4
  v_add_u32 v93, 82176, v5
  v_add_u32 v94, 82176, v6
  v_add_u32 v95, 82176, v7
  s_barrier
  s_waitcnt lgkmcnt(3)
  ds_read_b128 v[128:131], v2 offset:41088
  ds_read_b128 v[132:135], v2 offset:43136
  ds_read_b128 v[136:139], v3 offset:41088
  ds_read_b128 v[140:143], v3 offset:43136
  ds_read_b64_tr_b16 v[44:45], v4 offset:41088
  s_waitcnt vmcnt(0)
  v_mfma_f32_16x16x32_bf16 v[96:99], v[12:15], v[28:31], 0
  ds_read_b64_tr_b16 v[46:47], v4 offset:41600
  v_xor_b32 v9, v68, v52
  v_mfma_f32_16x16x32_bf16 v[100:103], v[16:19], v[28:31], 0
  ds_read_b64_tr_b16 v[28:29], v5 offset:41088
  v_and_b32 v68, s57, v68
  v_mfma_f32_16x16x32_bf16 v[104:107], v[12:15], v[32:35], 0
  ds_read_b64_tr_b16 v[30:31], v5 offset:41600
  v_add_u32 v2, 82176, v2
  v_mfma_f32_16x16x32_bf16 v[108:111], v[16:19], v[32:35], 0
  ds_read_b64_tr_b16 v[32:33], v4 offset:45184
  v_add_u32 v3, 82176, v3
  s_waitcnt lgkmcnt(11)
  v_mfma_f32_16x16x32_bf16 v[96:99], v[20:23], v[36:39], v[96:99]
  ds_read_b64_tr_b16 v[34:35], v4 offset:45696
  v_bitop3_b32 v9, v9, v69, v53 bitop3:0xf6
  v_mfma_f32_16x16x32_bf16 v[100:103], v[24:27], v[36:39], v[100:103]
  ds_read_b64_tr_b16 v[36:37], v5 offset:45184
  v_and_b32 v69, s57, v69
  s_waitcnt lgkmcnt(11)
  v_mfma_f32_16x16x32_bf16 v[104:107], v[20:23], v[40:43], v[104:107]
  ds_read_b64_tr_b16 v[38:39], v5 offset:45696
  v_bitop3_b32 v9, v9, v70, v54 bitop3:0xf6
  v_mfma_f32_16x16x32_bf16 v[108:111], v[24:27], v[40:43], v[108:111]
  s_barrier
  ds_read_b64_tr_b16 v[40:41], v92 offset:0
  s_waitcnt lgkmcnt(7)
  v_mfma_f32_16x16x32_bf16 v[96:99], v[128:131], v[44:47], v[96:99]
  ds_read_b64_tr_b16 v[42:43], v92 offset:512
  ds_read_b128 v[144:147], v2 offset:0
  v_mfma_f32_16x16x32_bf16 v[100:103], v[132:135], v[44:47], v[100:103]
  ds_read_b64_tr_b16 v[44:45], v93 offset:0
  ds_read_b128 v[148:151], v2 offset:2048
  s_waitcnt lgkmcnt(9)
  v_mfma_f32_16x16x32_bf16 v[104:107], v[128:131], v[28:31], v[104:107]
  ds_read_b64_tr_b16 v[46:47], v93 offset:512
  ds_read_b128 v[152:155], v3 offset:0
  v_mfma_f32_16x16x32_bf16 v[108:111], v[132:135], v[28:31], v[108:111]
  ds_read_b64_tr_b16 v[28:29], v92 offset:4096
  ds_read_b128 v[156:159], v3 offset:2048
  s_waitcnt lgkmcnt(9)
  v_mfma_f32_16x16x32_bf16 v[96:99], v[136:139], v[32:35], v[96:99]
  ds_read_b64_tr_b16 v[30:31], v92 offset:4608
  v_and_b32 v70, s57, v70
  v_mfma_f32_16x16x32_bf16 v[100:103], v[140:143], v[32:35], v[100:103]
  ds_read_b64_tr_b16 v[32:33], v93 offset:4096
  v_bitop3_b32 v9, v9, v71, v55 bitop3:0xf6
  v_mfma_f32_16x16x32_bf16 v[104:107], v[136:139], v[36:39], v[104:107]
  ds_read_b64_tr_b16 v[34:35], v93 offset:4608
  v_and_b32 v71, s57, v71
  v_mfma_f32_16x16x32_bf16 v[108:111], v[140:143], v[36:39], v[108:111]
  ds_read_b64_tr_b16 v[36:37], v4 offset:64
  v_bitop3_b32 v9, v9, v72, v52 bitop3:0xf6
  s_waitcnt lgkmcnt(7)
  v_mfma_f32_16x16x32_bf16 v[96:99], v[144:147], v[40:43], v[96:99]
  ds_read_b64_tr_b16 v[38:39], v4 offset:576
  v_and_b32 v72, s57, v72
  v_mfma_f32_16x16x32_bf16 v[100:103], v[148:151], v[40:43], v[100:103]
  ds_read_b64_tr_b16 v[40:41], v5 offset:64
  v_bitop3_b32 v9, v9, v73, v53 bitop3:0xf6
  v_mfma_f32_16x16x32_bf16 v[104:107], v[144:147], v[44:47], v[104:107]
  ds_read_b64_tr_b16 v[42:43], v5 offset:576
  v_and_b32 v73, s57, v73
  v_mfma_f32_16x16x32_bf16 v[108:111], v[148:151], v[44:47], v[108:111]
  ds_read_b64_tr_b16 v[44:45], v4 offset:4160
  v_bitop3_b32 v9, v9, v74, v54 bitop3:0xf6
  s_waitcnt lgkmcnt(5)
  v_mfma_f32_16x16x32_bf16 v[96:99], v[152:155], v[28:31], v[96:99]
  ds_read_b64_tr_b16 v[46:47], v4 offset:4672
  v_and_b32 v74, s57, v74
  v_mfma_f32_16x16x32_bf16 v[100:103], v[156:159], v[28:31], v[100:103]
  ds_read_b64_tr_b16 v[28:29], v5 offset:4160
  v_bitop3_b32 v9, v9, v75, v55 bitop3:0xf6
  v_mfma_f32_16x16x32_bf16 v[104:107], v[152:155], v[32:35], v[104:107]
  ds_read_b64_tr_b16 v[30:31], v5 offset:4672
  v_and_b32 v75, s57, v75
  v_mfma_f32_16x16x32_bf16 v[108:111], v[156:159], v[32:35], v[108:111]
  ds_read_b64_tr_b16 v[32:33], v4 offset:41152
  v_and_b32 v9, s56, v9
  s_waitcnt lgkmcnt(5)
  v_mfma_f32_16x16x32_bf16 v[112:115], v[12:15], v[36:39], 0
  ds_read_b64_tr_b16 v[34:35], v4 offset:41664
  v_cvt_pk_bf16_f32 v76, v96, v97
  v_mfma_f32_16x16x32_bf16 v[116:119], v[16:19], v[36:39], 0
  ds_read_b64_tr_b16 v[36:37], v5 offset:41152
  v_cvt_pk_bf16_f32 v77, v98, v99
  v_mfma_f32_16x16x32_bf16 v[120:123], v[12:15], v[40:43], 0
  ds_read_b64_tr_b16 v[38:39], v5 offset:41664
  v_cvt_pk_bf16_f32 v78, v100, v101
  v_mfma_f32_16x16x32_bf16 v[124:127], v[16:19], v[40:43], 0
  ds_read_b64_tr_b16 v[40:41], v4 offset:45248
  v_cmp_ne_u32 vcc, 0, v9
  s_cbranch_vccnz L_s3
L_s3_ok:
  s_cmp_eq_u32 s34, s41
  s_cselect_b64 vcc, -1, 0
  s_waitcnt lgkmcnt(5)
  v_mfma_f32_16x16x32_bf16 v[112:115], v[20:23], v[44:47], v[112:115]
  ds_read_b64_tr_b16 v[42:43], v4 offset:45760
  v_cvt_pk_bf16_f32 v79, v102, v103
  v_mfma_f32_16x16x32_bf16 v[116:119], v[24:27], v[44:47], v[116:119]
  ds_read_b64_tr_b16 v[44:45], v5 offset:45248
  v_cvt_pk_bf16_f32 v80, v104, v105
  v_mfma_f32_16x16x32_bf16 v[176:179], v[76:79], v[68:71], v[176:179]
  v_cvt_pk_bf16_f32 v81, v106, v107
  v_cvt_pk_bf16_f32 v82, v108, v109
  v_mfma_f32_16x16x32_bf16 v[120:123], v[20:23], v[28:31], v[120:123]
  ds_read_b64_tr_b16 v[46:47], v5 offset:45760
  v_cvt_pk_bf16_f32 v83, v110, v111
  v_mfma_f32_16x16x32_bf16 v[124:127], v[24:27], v[28:31], v[124:127]
  ds_read_b64_tr_b16 v[28:29], v92 offset:64
  v_mfma_f32_16x16x32_bf16 v[184:187], v[76:79], v[72:75], v[184:187]
  v_mfma_f32_16x16x32_bf16 v[180:183], v[80:83], v[68:71], v[180:183]
  s_waitcnt lgkmcnt(5)
  v_mfma_f32_16x16x32_bf16 v[112:115], v[128:131], v[32:35], v[112:115]
  ds_read_b64_tr_b16 v[30:31], v92 offset:576
  v_mfma_f32_16x16x32_bf16 v[116:119], v[132:135], v[32:35], v[116:119]
  ds_read_b64_tr_b16 v[32:33], v93 offset:64
  v_mfma_f32_16x16x32_bf16 v[120:123], v[128:131], v[36:39], v[120:123]
  ds_read_b64_tr_b16 v[34:35], v93 offset:576
  v_perm_b32 v176, v177, v176, s59
  v_mfma_f32_16x16x32_bf16 v[124:127], v[132:135], v[36:39], v[124:127]
  ds_read_b64_tr_b16 v[36:37], v92 offset:4160
  v_mfma_f32_16x16x32_bf16 v[188:191], v[80:83], v[72:75], v[188:191]
  v_perm_b32 v177, v179, v178, s59
  v_perm_b32 v178, v181, v180, s59
  s_waitcnt lgkmcnt(5)
  v_mfma_f32_16x16x32_bf16 v[112:115], v[136:139], v[40:43], v[112:115]
  ds_read_b64_tr_b16 v[38:39], v92 offset:4672
  v_perm_b32 v179, v183, v182, s59
  v_mfma_f32_16x16x32_bf16 v[116:119], v[140:143], v[40:43], v[116:119]
  ds_read_b64_tr_b16 v[40:41], v93 offset:4160
  v_bfi_b32 v176, s58, v52, v176
  v_mfma_f32_16x16x32_bf16 v[120:123], v[136:139], v[44:47], v[120:123]
  ds_read_b64_tr_b16 v[42:43], v93 offset:4672
  v_bfi_b32 v177, s58, v53, v177
  v_mfma_f32_16x16x32_bf16 v[124:127], v[140:143], v[44:47], v[124:127]
  ds_read_b64_tr_b16 v[44:45], v4 offset:1024
  s_waitcnt lgkmcnt(5)
  v_mfma_f32_16x16x32_bf16 v[112:115], v[144:147], v[28:31], v[112:115]
  ds_read_b64_tr_b16 v[46:47], v4 offset:1536
  v_bfi_b32 v178, s58, v54, v178
  v_mfma_f32_16x16x32_bf16 v[116:119], v[148:151], v[28:31], v[116:119]
  ds_read_b64_tr_b16 v[28:29], v5 offset:1024
  v_bfi_b32 v179, s58, v55, v179
  v_mfma_f32_16x16x32_bf16 v[120:123], v[144:147], v[32:35], v[120:123]
  ds_read_b64_tr_b16 v[30:31], v5 offset:1536
  buffer_store_dwordx4 v[176:179], v56, s[28:31], s64 offen offset:0 sc1
  v_mfma_f32_16x16x32_bf16 v[124:127], v[148:151], v[32:35], v[124:127]
  ds_read_b64_tr_b16 v[32:33], v4 offset:5120
  s_waitcnt lgkmcnt(5)
  v_mfma_f32_16x16x32_bf16 v[112:115], v[152:155], v[36:39], v[112:115]
  ds_read_b64_tr_b16 v[34:35], v4 offset:5632
  v_perm_b32 v180, v185, v184, s59
  v_mfma_f32_16x16x32_bf16 v[116:119], v[156:159], v[36:39], v[116:119]
  ds_read_b64_tr_b16 v[36:37], v5 offset:5120
  v_perm_b32 v181, v187, v186, s59
  v_mfma_f32_16x16x32_bf16 v[120:123], v[152:155], v[40:43], v[120:123]
  ds_read_b64_tr_b16 v[38:39], v5 offset:5632
  v_perm_b32 v182, v189, v188, s59
  v_mfma_f32_16x16x32_bf16 v[124:127], v[156:159], v[40:43], v[124:127]
  ds_read_b64_tr_b16 v[40:41], v4 offset:42112
  s_waitcnt lgkmcnt(5)
  v_mfma_f32_16x16x32_bf16 v[96:99], v[12:15], v[44:47], 0
  ds_read_b64_tr_b16 v[42:43], v4 offset:42624
  v_cvt_pk_bf16_f32 v76, v112, v113
  v_mfma_f32_16x16x32_bf16 v[100:103], v[16:19], v[44:47], 0
  ds_read_b64_tr_b16 v[44:45], v5 offset:42112
  v_cvt_pk_bf16_f32 v77, v114, v115
  v_mfma_f32_16x16x32_bf16 v[104:107], v[12:15], v[28:31], 0
  ds_read_b64_tr_b16 v[46:47], v5 offset:42624
  v_cvt_pk_bf16_f32 v78, v116, v117
  v_mfma_f32_16x16x32_bf16 v[108:111], v[16:19], v[28:31], 0
  ds_read_b64_tr_b16 v[28:29], v4 offset:46208
  s_waitcnt lgkmcnt(5)
  v_mfma_f32_16x16x32_bf16 v[96:99], v[20:23], v[32:35], v[96:99]
  ds_read_b64_tr_b16 v[30:31], v4 offset:46720
  v_cvt_pk_bf16_f32 v79, v118, v119
  v_mfma_f32_16x16x32_bf16 v[100:103], v[24:27], v[32:35], v[100:103]
  ds_read_b64_tr_b16 v[32:33], v5 offset:46208
  v_cvt_pk_bf16_f32 v80, v120, v121
  v_mfma_f32_16x16x32_bf16 v[192:195], v[76:79], v[68:71], v[192:195]
  v_cvt_pk_bf16_f32 v81, v122, v123
  v_cvt_pk_bf16_f32 v82, v124, v125
  v_mfma_f32_16x16x32_bf16 v[104:107], v[20:23], v[36:39], v[104:107]
  ds_read_b64_tr_b16 v[34:35], v5 offset:46720
  v_cvt_pk_bf16_f32 v83, v126, v127
  v_mfma_f32_16x16x32_bf16 v[108:111], v[24:27], v[36:39], v[108:111]
  ds_read_b64_tr_b16 v[36:37], v92 offset:1024
  v_mfma_f32_16x16x32_bf16 v[200:203], v[76:79], v[72:75], v[200:203]
  v_perm_b32 v183, v191, v190, s59
  v_bfi_b32 v180, s58, v52, v180
  v_mfma_f32_16x16x32_bf16 v[196:199], v[80:83], v[68:71], v[196:199]
  v_bfi_b32 v181, s58, v53, v181
  v_bfi_b32 v182, s58, v54, v182
  s_waitcnt lgkmcnt(5)
  v_mfma_f32_16x16x32_bf16 v[96:99], v[128:131], v[40:43], v[96:99]
  ds_read_b64_tr_b16 v[38:39], v92 offset:1536
  v_bfi_b32 v183, s58, v55, v183
  v_mfma_f32_16x16x32_bf16 v[100:103], v[132:135], v[40:43], v[100:103]
  ds_read_b64_tr_b16 v[40:41], v93 offset:1024
  buffer_store_dwordx4 v[180:183], v57, s[28:31], s66 offen offset:0 sc1
  s_cbranch_vccnz L_own0
L_ownr0:
  v_mfma_f32_16x16x32_bf16 v[104:107], v[128:131], v[44:47], v[104:107]
  ds_read_b64_tr_b16 v[42:43], v93 offset:1536
  v_perm_b32 v192, v193, v192, s59
  v_mfma_f32_16x16x32_bf16 v[108:111], v[132:135], v[44:47], v[108:111]
  ds_read_b64_tr_b16 v[44:45], v92 offset:5120
  v_mfma_f32_16x16x32_bf16 v[204:207], v[80:83], v[72:75], v[204:207]
  v_perm_b32 v193, v195, v194, s59
  v_perm_b32 v194, v197, v196, s59
  s_waitcnt lgkmcnt(5)
  v_mfma_f32_16x16x32_bf16 v[96:99], v[136:139], v[28:31], v[96:99]
  ds_read_b64_tr_b16 v[46:47], v92 offset:5632
  v_perm_b32 v195, v199, v198, s59
  v_mfma_f32_16x16x32_bf16 v[100:103], v[140:143], v[28:31], v[100:103]
  ds_read_b64_tr_b16 v[28:29], v93 offset:5120
  v_bfi_b32 v192, s58, v52, v192
  v_mfma_f32_16x16x32_bf16 v[104:107], v[136:139], v[32:35], v[104:107]
  ds_read_b64_tr_b16 v[30:31], v93 offset:5632
  v_bfi_b32 v193, s58, v53, v193
  v_mfma_f32_16x16x32_bf16 v[108:111], v[140:143], v[32:35], v[108:111]
  ds_read_b64_tr_b16 v[32:33], v4 offset:1088
  s_waitcnt lgkmcnt(5)
  v_mfma_f32_16x16x32_bf16 v[96:99], v[144:147], v[36:39], v[96:99]
  ds_read_b64_tr_b16 v[34:35], v4 offset:1600
  v_bfi_b32 v194, s58, v54, v194
  v_mfma_f32_16x16x32_bf16 v[100:103], v[148:151], v[36:39], v[100:103]
  ds_read_b64_tr_b16 v[36:37], v5 offset:1088
  v_bfi_b32 v195, s58, v55, v195
  v_mfma_f32_16x16x32_bf16 v[104:107], v[144:147], v[40:43], v[104:107]
  ds_read_b64_tr_b16 v[38:39], v5 offset:1600
  buffer_store_dwordx4 v[192:195], v56, s[28:31], s64 offen offset:1024 sc1
  v_mfma_f32_16x16x32_bf16 v[108:111], v[148:151], v[40:43], v[108:111]
  ds_read_b64_tr_b16 v[40:41], v4 offset:5184
  s_waitcnt lgkmcnt(5)
  v_mfma_f32_16x16x32_bf16 v[96:99], v[152:155], v[44:47], v[96:99]
  ds_read_b64_tr_b16 v[42:43], v4 offset:5696
  v_perm_b32 v196, v201, v200, s59
  v_mfma_f32_16x16x32_bf16 v[100:103], v[156:159], v[44:47], v[100:103]
  ds_read_b64_tr_b16 v[44:45], v5 offset:5184
  v_perm_b32 v197, v203, v202, s59
  v_mfma_f32_16x16x32_bf16 v[104:107], v[152:155], v[28:31], v[104:107]
  ds_read_b64_tr_b16 v[46:47], v5 offset:5696
  v_perm_b32 v198, v205, v204, s59
  v_mfma_f32_16x16x32_bf16 v[108:111], v[156:159], v[28:31], v[108:111]
  ds_read_b64_tr_b16 v[28:29], v4 offset:42176
  s_waitcnt lgkmcnt(5)
  v_mfma_f32_16x16x32_bf16 v[112:115], v[12:15], v[32:35], 0
  ds_read_b64_tr_b16 v[30:31], v4 offset:42688
  v_cvt_pk_bf16_f32 v76, v96, v97
  v_mfma_f32_16x16x32_bf16 v[116:119], v[16:19], v[32:35], 0
  ds_read_b64_tr_b16 v[32:33], v5 offset:42176
  v_cvt_pk_bf16_f32 v77, v98, v99
  v_mfma_f32_16x16x32_bf16 v[120:123], v[12:15], v[36:39], 0
  ds_read_b64_tr_b16 v[34:35], v5 offset:42688
  v_cvt_pk_bf16_f32 v78, v100, v101
  v_mfma_f32_16x16x32_bf16 v[124:127], v[16:19], v[36:39], 0
  ds_read_b64_tr_b16 v[36:37], v4 offset:46272
  s_waitcnt lgkmcnt(5)
  v_mfma_f32_16x16x32_bf16 v[112:115], v[20:23], v[40:43], v[112:115]
  ds_read_b64_tr_b16 v[38:39], v4 offset:46784
  v_cvt_pk_bf16_f32 v79, v102, v103
  v_mfma_f32_16x16x32_bf16 v[116:119], v[24:27], v[40:43], v[116:119]
  ds_read_b64_tr_b16 v[40:41], v5 offset:46272
  v_cvt_pk_bf16_f32 v80, v104, v105
  v_mfma_f32_16x16x32_bf16 v[208:211], v[76:79], v[68:71], v[208:211]
  v_cvt_pk_bf16_f32 v81, v106, v107
  v_cvt_pk_bf16_f32 v82, v108, v109
  v_mfma_f32_16x16x32_bf16 v[120:123], v[20:23], v[44:47], v[120:123]
  ds_read_b64_tr_b16 v[42:43], v5 offset:46784
  v_cvt_pk_bf16_f32 v83, v110, v111
  v_mfma_f32_16x16x32_bf16 v[124:127], v[24:27], v[44:47], v[124:127]
  ds_read_b64_tr_b16 v[44:45], v92 offset:1088
  v_mfma_f32_16x16x32_bf16 v[216:219], v[76:79], v[72:75], v[216:219]
  v_perm_b32 v199, v207, v206, s59
  v_bfi_b32 v196, s58, v52, v196
  v_mfma_f32_16x16x32_bf16 v[212:215], v[80:83], v[68:71], v[212:215]
  v_bfi_b32 v197, s58, v53, v197
  v_bfi_b32 v198, s58, v54, v198
  s_waitcnt lgkmcnt(5)
  v_mfma_f32_16x16x32_bf16 v[112:115], v[128:131], v[28:31], v[112:115]
  ds_read_b64_tr_b16 v[46:47], v92 offset:1600
  v_bfi_b32 v199, s58, v55, v199
  v_mfma_f32_16x16x32_bf16 v[116:119], v[132:135], v[28:31], v[116:119]
  ds_read_b64_tr_b16 v[28:29], v93 offset:1088
  buffer_store_dwordx4 v[196:199], v57, s[28:31], s66 offen offset:1024 sc1
  s_cbranch_vccnz L_own1
L_ownr1:
  v_mfma_f32_16x16x32_bf16 v[120:123], v[128:131], v[32:35], v[120:123]
  ds_read_b64_tr_b16 v[30:31], v93 offset:1600
  v_perm_b32 v208, v209, v208, s59
  v_mfma_f32_16x16x32_bf16 v[124:127], v[132:135], v[32:35], v[124:127]
  ds_read_b64_tr_b16 v[32:33], v92 offset:5184
  v_mfma_f32_16x16x32_bf16 v[220:223], v[80:83], v[72:75], v[220:223]
  v_perm_b32 v209, v211, v210, s59
  v_perm_b32 v210, v213, v212, s59
  s_waitcnt lgkmcnt(5)
  v_mfma_f32_16x16x32_bf16 v[112:115], v[136:139], v[36:39], v[112:115]
  ds_read_b64_tr_b16 v[34:35], v92 offset:5696
  v_perm_b32 v211, v215, v214, s59
  v_mfma_f32_16x16x32_bf16 v[116:119], v[140:143], v[36:39], v[116:119]
  ds_read_b64_tr_b16 v[36:37], v93 offset:5184
  v_bfi_b32 v208, s58, v52, v208
  v_mfma_f32_16x16x32_bf16 v[120:123], v[136:139], v[40:43], v[120:123]
  ds_read_b64_tr_b16 v[38:39], v93 offset:5696
  v_bfi_b32 v209, s58, v53, v209
  v_mfma_f32_16x16x32_bf16 v[124:127], v[140:143], v[40:43], v[124:127]
  ds_read_b64_tr_b16 v[40:41], v6 offset:0
  s_waitcnt lgkmcnt(5)
  v_mfma_f32_16x16x32_bf16 v[112:115], v[144:147], v[44:47], v[112:115]
  ds_read_b64_tr_b16 v[42:43], v6 offset:256
  v_bfi_b32 v210, s58, v54, v210
  v_mfma_f32_16x16x32_bf16 v[116:119], v[148:151], v[44:47], v[116:119]
  ds_read_b64_tr_b16 v[44:45], v7 offset:0
  v_bfi_b32 v211, s58, v55, v211
  v_mfma_f32_16x16x32_bf16 v[120:123], v[144:147], v[28:31], v[120:123]
  ds_read_b64_tr_b16 v[46:47], v7 offset:256
  buffer_store_dwordx4 v[208:211], v56, s[28:31], s64 offen offset:2048 sc1
  v_mfma_f32_16x16x32_bf16 v[124:127], v[148:151], v[28:31], v[124:127]
  ds_read_b64_tr_b16 v[28:29], v6 offset:2048
  s_waitcnt lgkmcnt(5)
  v_mfma_f32_16x16x32_bf16 v[112:115], v[152:155], v[32:35], v[112:115]
  ds_read_b64_tr_b16 v[30:31], v6 offset:2304
  v_perm_b32 v212, v217, v216, s59
  v_mfma_f32_16x16x32_bf16 v[116:119], v[156:159], v[32:35], v[116:119]
  ds_read_b64_tr_b16 v[32:33], v7 offset:2048
  v_perm_b32 v213, v219, v218, s59
  v_mfma_f32_16x16x32_bf16 v[120:123], v[152:155], v[36:39], v[120:123]
  ds_read_b64_tr_b16 v[34:35], v7 offset:2304
  v_perm_b32 v214, v221, v220, s59
  v_mfma_f32_16x16x32_bf16 v[124:127], v[156:159], v[36:39], v[124:127]
  ds_read_b64_tr_b16 v[36:37], v6 offset:41088
  s_waitcnt lgkmcnt(5)
  v_mfma_f32_16x16x32_bf16 v[96:99], v[12:15], v[40:43], 0
  ds_read_b64_tr_b16 v[38:39], v6 offset:41344
  v_cvt_pk_bf16_f32 v76, v112, v113
  v_mfma_f32_16x16x32_bf16 v[100:103], v[16:19], v[40:43], 0
  ds_read_b64_tr_b16 v[40:41], v7 offset:41088
  v_cvt_pk_bf16_f32 v77, v114, v115
  v_mfma_f32_16x16x32_bf16 v[104:107], v[12:15], v[44:47], 0
  ds_read_b64_tr_b16 v[42:43], v7 offset:41344
  v_cvt_pk_bf16_f32 v78, v116, v117
  v_mfma_f32_16x16x32_bf16 v[108:111], v[16:19], v[44:47], 0
  ds_read_b64_tr_b16 v[44:45], v6 offset:43136
  s_waitcnt lgkmcnt(5)
  v_mfma_f32_16x16x32_bf16 v[96:99], v[20:23], v[28:31], v[96:99]
  ds_read_b64_tr_b16 v[46:47], v6 offset:43392
  v_cvt_pk_bf16_f32 v79, v118, v119
  v_mfma_f32_16x16x32_bf16 v[100:103], v[24:27], v[28:31], v[100:103]
  ds_read_b64_tr_b16 v[28:29], v7 offset:43136
  v_cvt_pk_bf16_f32 v80, v120, v121
  v_mfma_f32_16x16x32_bf16 v[224:227], v[76:79], v[68:71], v[224:227]
  v_cvt_pk_bf16_f32 v81, v122, v123
  v_cvt_pk_bf16_f32 v82, v124, v125
  v_mfma_f32_16x16x32_bf16 v[104:107], v[20:23], v[32:35], v[104:107]
  ds_read_b64_tr_b16 v[30:31], v7 offset:43392
  v_cvt_pk_bf16_f32 v83, v126, v127
  v_mfma_f32_16x16x32_bf16 v[108:111], v[24:27], v[32:35], v[108:111]
  ds_read_b64_tr_b16 v[32:33], v94 offset:0
  v_mfma_f32_16x16x32_bf16 v[232:235], v[76:79], v[72:75], v[232:235]
  v_perm_b32 v215, v223, v222, s59
  v_bfi_b32 v212, s58, v52, v212
  v_mfma_f32_16x16x32_bf16 v[228:231], v[80:83], v[68:71], v[228:231]
  v_bfi_b32 v213, s58, v53, v213
  v_bfi_b32 v214, s58, v54, v214
  s_waitcnt lgkmcnt(5)
  v_mfma_f32_16x16x32_bf16 v[96:99], v[128:131], v[36:39], v[96:99]
  ds_read_b64_tr_b16 v[34:35], v94 offset:256
  v_bfi_b32 v215, s58, v55, v215
  v_mfma_f32_16x16x32_bf16 v[100:103], v[132:135], v[36:39], v[100:103]
  ds_read_b64_tr_b16 v[36:37], v95 offset:0
  buffer_store_dwordx4 v[212:215], v57, s[28:31], s66 offen offset:2048 sc1
  s_cbranch_vccnz L_own2
L_ownr2:
  v_mfma_f32_16x16x32_bf16 v[104:107], v[128:131], v[40:43], v[104:107]
  ds_read_b64_tr_b16 v[38:39], v95 offset:256
  v_perm_b32 v224, v225, v224, s59
  v_mfma_f32_16x16x32_bf16 v[108:111], v[132:135], v[40:43], v[108:111]
  ds_read_b64_tr_b16 v[40:41], v94 offset:2048
  v_mfma_f32_16x16x32_bf16 v[236:239], v[80:83], v[72:75], v[236:239]
  v_perm_b32 v225, v227, v226, s59
  v_perm_b32 v226, v229, v228, s59
  s_waitcnt lgkmcnt(5)
  v_mfma_f32_16x16x32_bf16 v[96:99], v[136:139], v[44:47], v[96:99]
  ds_read_b64_tr_b16 v[42:43], v94 offset:2304
  v_perm_b32 v227, v231, v230, s59
  v_mfma_f32_16x16x32_bf16 v[100:103], v[140:143], v[44:47], v[100:103]
  ds_read_b64_tr_b16 v[44:45], v95 offset:2048
  v_bfi_b32 v224, s58, v52, v224
  v_mfma_f32_16x16x32_bf16 v[104:107], v[136:139], v[28:31], v[104:107]
  ds_read_b64_tr_b16 v[46:47], v95 offset:2304
  v_bfi_b32 v225, s58, v53, v225
  v_mfma_f32_16x16x32_bf16 v[108:111], v[140:143], v[28:31], v[108:111]
  s_waitcnt lgkmcnt(4)
  v_mfma_f32_16x16x32_bf16 v[96:99], v[144:147], v[32:35], v[96:99]
  v_bfi_b32 v226, s58, v54, v226
  v_mfma_f32_16x16x32_bf16 v[100:103], v[148:151], v[32:35], v[100:103]
  v_bfi_b32 v227, s58, v55, v227
  v_mfma_f32_16x16x32_bf16 v[104:107], v[144:147], v[36:39], v[104:107]
  buffer_store_dwordx4 v[224:227], v56, s[28:31], s64 offen offset:3072 sc1
  v_mfma_f32_16x16x32_bf16 v[108:111], v[148:151], v[36:39], v[108:111]
  s_waitcnt lgkmcnt(0)
  v_mfma_f32_16x16x32_bf16 v[96:99], v[152:155], v[40:43], v[96:99]
  v_perm_b32 v228, v233, v232, s59
  v_mfma_f32_16x16x32_bf16 v[100:103], v[156:159], v[40:43], v[100:103]
  v_perm_b32 v229, v235, v234, s59
  v_mfma_f32_16x16x32_bf16 v[104:107], v[152:155], v[44:47], v[104:107]
  v_perm_b32 v230, v237, v236, s59
  v_mfma_f32_16x16x32_bf16 v[108:111], v[156:159], v[44:47], v[108:111]
  s_nop 1
  v_cvt_pk_bf16_f32 v76, v96, v97
  v_cvt_pk_bf16_f32 v77, v98, v99
  v_cvt_pk_bf16_f32 v78, v100, v101
  v_cvt_pk_bf16_f32 v79, v102, v103
  v_perm_b32 v231, v239, v238, s59
  v_bfi_b32 v228, s58, v52, v228
  v_mfma_f32_16x16x32_bf16 v[240:243], v[76:79], v[68:71], v[240:243]
  v_cvt_pk_bf16_f32 v80, v104, v105
  v_cvt_pk_bf16_f32 v81, v106, v107
  v_mfma_f32_16x16x32_bf16 v[248:251], v[76:79], v[72:75], v[248:251]
  v_cvt_pk_bf16_f32 v82, v108, v109
  v_cvt_pk_bf16_f32 v83, v110, v111
  v_bfi_b32 v229, s58, v53, v229
  v_bfi_b32 v230, s58, v54, v230
  v_mfma_f32_16x16x32_bf16 v[244:247], v[80:83], v[68:71], v[244:247]
  v_bfi_b32 v231, s58, v55, v231
  buffer_store_dwordx4 v[228:231], v57, s[28:31], s66 offen offset:3072 sc1
  v_mfma_f32_16x16x32_bf16 v[252:255], v[80:83], v[72:75], v[252:255]
  s_cbranch_vccnz L_own3
L_ownr3:
  v_perm_b32 v240, v241, v240, s59
  v_perm_b32 v241, v243, v242, s59
  s_nop 1
  v_perm_b32 v242, v245, v244, s59
  v_perm_b32 v243, v247, v246, s59
  v_bfi_b32 v240, s58, v52, v240
  v_bfi_b32 v241, s58, v53, v241
  v_bfi_b32 v242, s58, v54, v242
  v_bfi_b32 v243, s58, v55, v243
  buffer_store_dwordx4 v[240:243], v56, s[28:31], s65 offen offset:0 sc1
  v_perm_b32 v244, v249, v248, s59
  v_perm_b32 v245, v251, v250, s59
  v_perm_b32 v246, v253, v252, s59
  v_perm_b32 v247, v255, v254, s59
  v_bfi_b32 v244, s58, v52, v244
  v_bfi_b32 v245, s58, v53, v245
  v_bfi_b32 v246, s58, v54, v246
  v_bfi_b32 v247, s58, v55, v247
  buffer_store_dwordx4 v[244:247], v57, s[28:31], s67 offen offset:0 sc1
  s_cbranch_vccnz L_own4
L_ownr4:
  s_mov_b32 s60, 4
  s_waitcnt lgkmcnt(0)
  s_barrier
  s_cmp_lg_u32 s41, 0
  s_cbranch_scc1 L_cdone
  s_lshl_b32 s44, s33, 2
  s_add_u32 s44, s44, s40
  s_mul_i32 s44, s44, 327680
  s_mul_i32 s45, s39, 40960
  s_add_u32 s44, s44, s45
  s_lshl_b32 s45, s60, 10
  s_add_u32 s44, s44, s45
  s_add_u32 s61, s44, 2097152
  s_lshl_b32 s46, s37, 3
  s_add_u32 s46, s46, s39
  s_mul_i32 s46, s46, 40960
  s_mul_i32 s45, s36, 1280
  s_add_u32 s46, s46, s45
  s_mul_i32 s45, s40, 320
  s_add_u32 s46, s46, s45
  s_and_b32 s45, s40, 1
  s_add_u32 s45, s45, s60
  s_cmp_eq_u32 s45, 5
  s_cselect_b32 s45, 0, s45
  s_lshl_b32 s45, s45, 6
  s_add_u32 s62, s46, s45
  s_mov_b32 s24, s86
  s_mov_b32 s25, s87
  s_mov_b32 s26, 1310720
  s_mov_b32 s27, 0x00020000
  v_lshlrev_b32 v2, 4, v0
  v_and_b32 v4, 15, v0
  v_mul_u32_u24 v4, 2560, v4
  v_bfe_u32 v5, v0, 4, 1
  v_lshl_add_u32 v4, v5, 5, v4
  v_lshrrev_b32 v5, 5, v0
  v_lshl_add_u32 v4, v5, 4, v4
  s_lshl_b32 s45, s60, 1
  s_and_b32 s46, s39, 1
  s_add_u32 s45, s45, s46
  s_lshl_b32 s45, s45, 10
  v_add_u32 v6, s45, v2
  s_add_u32 s45, s39, 1
  s_and_b32 s45, s45, 7
  s_mul_i32 s45, s45, 5120
  s_add_u32 s77, s61, s45
  s_add_u32 s45, s39, 2
  s_and_b32 s45, s45, 7
  s_mul_i32 s45, s45, 5120
  s_add_u32 s78, s61, s45
  s_add_u32 s45, s39, 3
  s_and_b32 s45, s45, 7
  s_mul_i32 s45, s45, 5120
  s_add_u32 s79, s61, s45
  s_add_u32 s45, s39, 4
  s_and_b32 s45, s45, 7
  s_mul_i32 s45, s45, 5120
  s_add_u32 s80, s61, s45
  s_add_u32 s45, s39, 5
  s_and_b32 s45, s45, 7
  s_mul_i32 s45, s45, 5120
  s_add_u32 s81, s61, s45
  s_add_u32 s45, s39, 6
  s_and_b32 s45, s45, 7
  s_mul_i32 s45, s45, 5120
  s_add_u32 s82, s61, s45
  s_add_u32 s45, s39, 7
  s_and_b32 s45, s45, 7
  s_mul_i32 s45, s45, 5120
  s_add_u32 s83, s61, s45
  v_mov_b32 v3, 0xffff0000
  s_mov_b32 s47, 0x10000
  s_branch L_reduce
L_cdone:
  s_endpgm
L_own0:
  ds_write_b128 v1, v[176:179] offset:0
  ds_write_b128 v1, v[180:183] offset:1024
  s_branch L_ownr0
L_own1:
  ds_write_b128 v1, v[192:195] offset:2048
  ds_write_b128 v1, v[196:199] offset:3072
  s_branch L_ownr1
L_own2:
  ds_write_b128 v1, v[208:211] offset:4096
  ds_write_b128 v1, v[212:215] offset:5120
  s_branch L_ownr2
L_own3:
  ds_write_b128 v1, v[224:227] offset:6144
  ds_write_b128 v1, v[228:231] offset:7168
  s_branch L_ownr3
L_own4:
  ds_write_b128 v1, v[240:243] offset:8192
  ds_write_b128 v1, v[244:247] offset:9216
  s_branch L_ownr4
L_end:
.section .rodata,"a"
.p2align 6
.amdhsa_kernel concat_heads__gqa_block_cached__gqa_block_cached__near_ridge_kernel
  .amdhsa_next_free_vgpr 256
  .amdhsa_next_free_sgpr 102
  .amdhsa_accum_offset 256
  .amdhsa_group_segment_fixed_size 0
  .amdhsa_kernarg_size 104
  .amdhsa_user_sgpr_count 2
  .amdhsa_user_sgpr_kernarg_segment_ptr 1
  .amdhsa_system_sgpr_workgroup_id_x 1
.end_amdhsa_kernel
```
